```python
import torch

def _softmax(x, axis=-1):
    return torch.softmax(x, dim=axis)
def _gelu(x):
    return torch.nn.functional.gelu(x, approximate="tanh")
def _silu(x):
    return torch.nn.functional.silu(x)
def _sigmoid(x):
    return torch.sigmoid(x)
def _layernorm(x, axis=-1, eps=1e-5):
    m = x.mean(dim=axis, keepdim=True)
    v = x.var(dim=axis, keepdim=True, unbiased=False)
    return (x - m) / torch.sqrt(v + eps)
def _scatter_add(tgt, idx, src, axis=0):
    return tgt.clone().index_add_(axis, idx, src)
def _segment_sum(src, seg, n):
    out = torch.zeros((n,) + src.shape[1:], dtype=src.dtype)
    return out.index_add_(0, seg, src)
def _pad(x, pw):
    flat = tuple(v for pair in reversed(pw) for v in pair)
    return torch.nn.functional.pad(x, flat)

kernel_name = 'parallel_sum__linear_kernel_hedgehog__geglu_ffn__prompt'

def setup_inputs():

    _w = (lambda a: (lambda t: t.to(torch.bfloat16) if t.is_floating_point() else t)(torch.as_tensor(a)))
    def _A_setup():
        B, S, D, H = 1, 2048, 448, 16
        Dh = D // H
        return {
            "x": _w((lambda *s: torch.randn(*s, dtype=torch.bfloat16) * 0.05)(B, S, D)),
            "wqkv": _w((lambda *s: torch.randn(*s, dtype=torch.bfloat16) * 0.8)(D, 3 * D)),
            "w_phi": _w((lambda *s: torch.randn(*s, dtype=torch.bfloat16) * 0.8)(H, Dh, Dh) * (Dh ** -0.5)),
            "wo": _w((lambda *s: torch.randn(*s, dtype=torch.bfloat16) * 0.2)(D, D)),
        }
    _A_in = _A_setup()

    def _B_setup():
        B, S, D, F = 1, 2048, 448, 1792
        return {
            "x": _w((lambda *s: torch.randn(*s, dtype=torch.bfloat16) * 0.05)(B, S, D)),
            "w_gate": _w((lambda *s: torch.randn(*s, dtype=torch.bfloat16) * 0.1)(D, F)),
            "w_up": _w((lambda *s: torch.randn(*s, dtype=torch.bfloat16) * 0.1)(D, F)),
            "w_down": _w((lambda *s: torch.randn(*s, dtype=torch.bfloat16) * 0.1)(F, D)),
        }
    _B_in = _B_setup()

    return {
        "A_x": _A_in["x"],
        "A_wqkv": _A_in["wqkv"],
        "A_w_phi": _A_in["w_phi"],
        "A_wo": _A_in["wo"],
        "B_x": _B_in["x"],
        "B_w_gate": _B_in["w_gate"],
        "B_w_up": _B_in["w_up"],
        "B_w_down": _B_in["w_down"],
    }

def reference(A_x, A_wqkv, A_w_phi, A_wo, B_x, B_w_gate, B_w_up, B_w_down):
    def _A_ref(x, wqkv, w_phi, wo):
        B, S, D = x.shape
        H = 16; Dh = D // H
        qkv = (lambda x, *d: x.permute(*d))((x @ wqkv).reshape(B, S, 3, H, Dh), 2, 0, 3, 1, 4)
        q, k, v = qkv[0], qkv[1], qkv[2]
        pq = torch.einsum("bhsd,hdf->bhsf", q, w_phi)
        pk = torch.einsum("bhsd,hdf->bhsf", k, w_phi)
        phi_q = torch.concatenate([_softmax(pq, axis=-1), _softmax(-pq, axis=-1)], axis=-1)
        phi_k = torch.concatenate([_softmax(pk, axis=-1), _softmax(-pk, axis=-1)], axis=-1)
        kv = torch.einsum("bhsf,bhsd->bhfd", phi_k, v)
        z  = torch.einsum("bhsf->bhf", phi_k)
        num = torch.einsum("bhqf,bhfd->bhqd", phi_q, kv)
        den = torch.einsum("bhqf,bhf->bhq", phi_q, z)[..., None] + 1e-6
        o = num / den
        return (lambda x, *d: x.permute(*d))(o, 0, 2, 1, 3).reshape(B, S, D) @ wo

    def _B_ref(x, w_gate, w_up, w_down):
        return (_gelu(x @ w_gate) * (x @ w_up)) @ w_down

    x = A_x
    xn = _layernorm(x, axis=-1)
    return x + _A_ref(xn, A_wqkv, A_w_phi, A_wo) + _B_ref(xn, B_w_gate, B_w_up, B_w_down)
```

```asm
; @launch grid=(256,1,1) block=(768,1,1) lds=163840
.amdgcn_target "amdgcn-amd-amdhsa--gfx950"
.text
.globl parallel_sum__linear_kernel_hedgehog__geglu_ffn__prompt_kernel
.p2align 8
.type parallel_sum__linear_kernel_hedgehog__geglu_ffn__prompt_kernel,@function
parallel_sum__linear_kernel_hedgehog__geglu_ffn__prompt_kernel:
    s_cmp_ge_u32 s2, 256
    s_cbranch_scc1 K_END
    s_load_dwordx16 s[4:19], s[0:1], 0
    s_load_dwordx4 s[20:23], s[0:1], 72
    s_load_dwordx2 s[28:29], s[0:1], 64
    v_lshrrev_b32 v136, 6, v0
    v_and_b32 v1, 63, v0
    v_readfirstlane_b32 s3, v136
    v_lshlrev_b32 v2, 4, v1
    v_mov_b32 v3, 0
    s_and_b32 s74, s2, 7
    s_lshr_b32 s75, s2, 3
    s_and_b32 s64, s74, 1
    s_lshl_b32 s64, s64, 2
    s_and_b32 s76, s75, 3
    s_add_u32 s64, s64, s76
    s_lshr_b32 s65, s74, 1
    s_lshr_b32 s75, s75, 2
    s_and_b32 s68, s75, 1
    s_lshr_b32 s66, s75, 1
    s_lshl_b32 s67, s65, 2
    s_add_u32 s67, s67, s66
    s_and_b32 s73, s67, 1
    s_lshl_b32 s76, s64, 2
    s_add_u32 s76, s76, s65
    s_lshl_b32 s76, s76, 3
    s_add_u32 s76, s76, s75
    s_lshl_b32 s76, s76, 3
    s_and_b32 s77, s3, 7
    s_add_u32 s86, s76, s77
    s_mov_b32 s80, 0
    s_mov_b32 s81, -1
    s_mul_i32 s74, s65, 896
    s_lshl_b32 s85, s66, 7
    s_add_u32 s77, s74, s85
    s_add_u32 s74, s74, 512
    s_mul_i32 s75, s66, 3
    s_and_b32 s76, s66, 1
    s_add_u32 s79, s75, s76
    s_lshl_b32 s76, s76, 1
    s_add_u32 s75, s75, 2
    s_sub_u32 s75, s75, s76
    s_lshl_b32 s75, s75, 5
    s_add_u32 s75, s75, s74
    s_lshl_b32 s79, s79, 5
    s_add_u32 s74, s74, s79
    s_cmp_eq_u32 s68, 1
    s_cselect_b32 s83, s75, s77
    s_cselect_b32 s84, s74, s77
    s_cmp_lt_u32 s3, 8
    s_cbranch_scc1 K_comp
K_helper:
    s_setprio 3
    s_sub_u32 s72, s3, 8
    s_lshl_b32 s74, s64, 2
    s_add_u32 s74, s74, s72
    s_mul_i32 s69, s74, 57344
    s_mul_i32 s70, s72, 24576
    v_lshrrev_b32 v143, 3, v1
    v_mul_u32_u24 v136, 896, v143
    v_and_b32 v144, 7, v1
    v_lshrrev_b32 v138, 4, v1
    v_xor_b32 v137, v144, v138
    v_lshl_add_u32 v4, v137, 4, v136
    v_xor_b32 v5, 64, v4
    s_mul_i32 s75, s67, 56
    s_lshl_b32 s76, s73, 3
    s_sub_u32 s75, s75, s76
    v_lshrrev_b32 v136, 2, v1
    v_and_b32 v137, 3, v1
    v_mul_u32_u24 v140, 2688, v136
    v_lshl_add_u32 v140, v137, 4, v140
    s_mul_i32 s85, s72, 43008
    s_add_u32 s75, s75, s85
    v_add_u32 v6, s75, v140
    s_waitcnt lgkmcnt(0)
    s_mov_b32 s24, s4
    s_mov_b32 s25, s5
    s_mov_b32 s26, 1835008
    s_mov_b32 s27, 0x20000
    s_mov_b32 s48, s6
    s_mov_b32 s49, s7
    s_mov_b32 s50, 1204224
    s_mov_b32 s51, 0x20000
    s_mov_b32 s32, s14
    s_mov_b32 s33, s15
    s_mov_b32 s34, 1605632
    s_mov_b32 s35, 0x20000
    s_mov_b32 s36, s16
    s_mov_b32 s37, s17
    s_mov_b32 s38, 1605632
    s_mov_b32 s39, 0x20000
    s_cmp_eq_u32 s68, 1
    s_cbranch_scc1 K_hkv
K_hq:
    v_bfe_u32 v138, v1, 4, 1
    v_lshlrev_b32 v138, 1, v138
    v_xor_b32 v138, v138, v144
    v_mul_u32_u24 v139, 3584, v143
    v_lshl_add_u32 v138, v138, 4, v139
    s_mul_i32 s85, s72, 57344
    s_add_u32 s85, s85, s83
    v_add_u32 v7, s85, v138
    v_xor_b32 v8, 64, v7
    s_lshl_b32 s71, s72, 10
    s_add_u32 s71, s71, 98304
    s_lshl_b32 s87, s72, 11
    s_add_u32 s87, s87, 98304
    s_add_u32 m0, s71, 16384
    s_mov_b32 s85, 0
    buffer_load_dwordx4 v6, s[48:51], s85 offen lds
    s_add_u32 m0, s87, 0
    s_mov_b32 s85, 0
    buffer_load_dwordx4 v7, s[32:35], s85 offen lds
    s_add_u32 m0, s87, 8192
    s_mov_b32 s85, 0
    buffer_load_dwordx4 v8, s[36:39], s85 offen lds
    s_add_u32 m0, s87, 1024
    s_mov_b32 s85, 28672
    buffer_load_dwordx4 v7, s[32:35], s85 offen lds
    s_add_u32 m0, s87, 9216
    s_mov_b32 s85, 28672
    buffer_load_dwordx4 v8, s[36:39], s85 offen lds
    s_add_u32 m0, s70, 0
    s_add_u32 s85, s69, 0
    buffer_load_dwordx4 v4, s[24:27], s85 offen lds
    s_add_u32 m0, s70, 1024
    s_add_u32 s85, s69, 7168
    buffer_load_dwordx4 v5, s[24:27], s85 offen lds
    s_add_u32 m0, s70, 2048
    s_add_u32 s85, s69, 14336
    buffer_load_dwordx4 v4, s[24:27], s85 offen lds
    s_add_u32 m0, s70, 3072
    s_add_u32 s85, s69, 21504
    buffer_load_dwordx4 v5, s[24:27], s85 offen lds
    s_add_u32 m0, s70, 12288
    s_add_u32 s85, s69, 28672
    buffer_load_dwordx4 v4, s[24:27], s85 offen lds
    s_add_u32 m0, s70, 13312
    s_add_u32 s85, s69, 35840
    buffer_load_dwordx4 v5, s[24:27], s85 offen lds
    s_add_u32 m0, s70, 14336
    s_add_u32 s85, s69, 43008
    buffer_load_dwordx4 v4, s[24:27], s85 offen lds
    s_add_u32 m0, s70, 15360
    s_add_u32 s85, s69, 50176
    buffer_load_dwordx4 v5, s[24:27], s85 offen lds
    v_lshrrev_b32 v63, 5, v1
    v_bfe_u32 v64, v1, 4, 1
    v_bfe_u32 v61, v1, 2, 2
    v_and_b32 v62, 3, v1
    v_lshl_add_u32 v65, v63, 3, v61
    v_lshlrev_b32 v66, 6, v65
    v_lshl_add_u32 v68, v64, 2, v62
    v_add_u32 v68, s73, v68
    v_and_b32 v68, 7, v68
    v_lshl_add_u32 v68, v68, 3, v66
    v_add_u32 v10, 114688, v68
    v_lshrrev_b32 v66, 1, v62
    v_and_b32 v67, 2, v61
    v_xor_b32 v66, v66, v67
    v_lshl_add_u32 v66, v64, 2, v66
    v_lshlrev_b32 v67, 7, v65
    v_lshl_add_u32 v67, v66, 4, v67
    v_and_b32 v66, 1, v62
    v_lshl_add_u32 v67, v66, 3, v67
    v_lshl_add_u32 v67, v64, 13, v67
    v_add_u32 v11, 98304, v67
    v_xor_b32 v12, 32, v11
    v_xor_b32 v13, 64, v11
    v_xor_b32 v14, 0x60, v11
    s_mul_i32 s74, s72, 1024
    v_add_u32 v10, s74, v10
    s_mul_i32 s74, s72, 2048
    v_add_u32 v11, s74, v11
    s_mul_i32 s74, s72, 2048
    v_add_u32 v12, s74, v12
    s_mul_i32 s74, s72, 2048
    v_add_u32 v13, s74, v13
    s_mul_i32 s74, s72, 2048
    v_add_u32 v14, s74, v14
    v_mov_b32 v18, 0
    v_mov_b32 v19, 0
    v_mov_b32 v20, 0
    v_mov_b32 v21, 0
    v_mov_b32 v22, 0
    s_add_u32 m0, s71, 36864
    s_mov_b32 s85, 172032
    buffer_load_dwordx4 v6, s[48:51], s85 offen lds
    s_add_u32 m0, s87, 20480
    s_mov_b32 s85, 229376
    buffer_load_dwordx4 v7, s[32:35], s85 offen lds
    s_add_u32 m0, s87, 28672
    s_mov_b32 s85, 229376
    buffer_load_dwordx4 v8, s[36:39], s85 offen lds
    s_add_u32 m0, s87, 21504
    s_mov_b32 s85, 258048
    buffer_load_dwordx4 v7, s[32:35], s85 offen lds
    s_add_u32 m0, s87, 29696
    s_mov_b32 s85, 258048
    buffer_load_dwordx4 v8, s[36:39], s85 offen lds
    s_add_u32 m0, s70, 4096
    s_add_u32 s85, s69, 128
    buffer_load_dwordx4 v4, s[24:27], s85 offen lds
    s_add_u32 m0, s70, 5120
    s_add_u32 s85, s69, 7296
    buffer_load_dwordx4 v5, s[24:27], s85 offen lds
    s_add_u32 m0, s70, 6144
    s_add_u32 s85, s69, 14464
    buffer_load_dwordx4 v4, s[24:27], s85 offen lds
    s_add_u32 m0, s70, 7168
    s_add_u32 s85, s69, 21632
    buffer_load_dwordx4 v5, s[24:27], s85 offen lds
    s_add_u32 m0, s70, 16384
    s_add_u32 s85, s69, 28800
    buffer_load_dwordx4 v4, s[24:27], s85 offen lds
    v_mov_b32 v140, 0
    v_mov_b32 v141, 0
    v_mov_b32 v142, 0
    v_mov_b32 v143, 0
    v_mov_b32 v144, 0
    v_mov_b32 v145, 0
    v_mov_b32 v146, 0
    v_mov_b32 v147, 0
    v_mov_b32 v148, 0
    v_mov_b32 v149, 0
    v_mov_b32 v150, 0
    v_mov_b32 v151, 0
    v_mov_b32 v152, 0
    v_mov_b32 v153, 0
    v_mov_b32 v154, 0
    v_mov_b32 v155, 0
    v_mov_b32 v156, 0
    v_mov_b32 v157, 0
    v_mov_b32 v158, 0
    v_mov_b32 v159, 0
    v_mov_b32 v134, 0x3f803f80
    v_mov_b32 v135, 0x3f803f80
    s_waitcnt vmcnt(10)
    s_barrier
    s_mov_b32 s40, s22
    s_mov_b32 s41, s23
    s_mov_b32 s42, 20971520
    s_mov_b32 s43, 0x20000
    s_mov_b32 s44, s20
    s_mov_b32 s45, s21
    s_mov_b32 s46, 256
    s_mov_b32 s47, 0x20000
    v_and_b32 v16, 7, v1
    v_lshlrev_b32 v16, 5, v16
    s_cmp_eq_u32 s3, 8
    s_cselect_b32 s74, 0, 0x40000000
    buffer_load_dword v17, v16, s[44:47], s74 offen sc1
    ds_read_b64_tr_b16 v[34:35], v10 offset:0
    ds_read_b64_tr_b16 v[36:37], v10 offset:256
    ds_read_b64_tr_b16 v[38:39], v11 offset:0
    ds_read_b64_tr_b16 v[40:41], v11 offset:512
    ds_read_b64_tr_b16 v[42:43], v12 offset:0
    ds_read_b64_tr_b16 v[44:45], v12 offset:512
    ds_read_b64_tr_b16 v[46:47], v13 offset:0
    ds_read_b64_tr_b16 v[48:49], v13 offset:512
    ds_read_b64_tr_b16 v[50:51], v14 offset:0
    ds_read_b64_tr_b16 v[52:53], v14 offset:512
    s_add_u32 m0, s70, 17408
    s_add_u32 s85, s69, 35968
    buffer_load_dwordx4 v5, s[24:27], s85 offen lds
    s_add_u32 m0, s70, 18432
    s_add_u32 s85, s69, 43136
    buffer_load_dwordx4 v4, s[24:27], s85 offen lds
    s_add_u32 m0, s70, 19456
    s_add_u32 s85, s69, 50304
    buffer_load_dwordx4 v5, s[24:27], s85 offen lds
    s_add_u32 m0, s71, 57344
    s_mov_b32 s85, 344064
    buffer_load_dwordx4 v6, s[48:51], s85 offen lds
    s_add_u32 m0, s87, 40960
    s_mov_b32 s85, 458752
    buffer_load_dwordx4 v7, s[32:35], s85 offen lds
    s_add_u32 m0, s87, 49152
    s_mov_b32 s85, 458752
    buffer_load_dwordx4 v8, s[36:39], s85 offen lds
    s_add_u32 m0, s87, 41984
    s_mov_b32 s85, 487424
    buffer_load_dwordx4 v7, s[32:35], s85 offen lds
    s_add_u32 m0, s87, 50176
    s_mov_b32 s85, 487424
    buffer_load_dwordx4 v8, s[36:39], s85 offen lds
    s_add_u32 m0, s70, 8192
    s_add_u32 s85, s69, 256
    buffer_load_dwordx4 v4, s[24:27], s85 offen lds
    s_add_u32 m0, s70, 9216
    s_add_u32 s85, s69, 7424
    buffer_load_dwordx4 v5, s[24:27], s85 offen lds
    s_add_u32 m0, s70, 10240
    s_add_u32 s85, s69, 14592
    buffer_load_dwordx4 v4, s[24:27], s85 offen lds
    s_add_u32 m0, s70, 11264
    s_add_u32 s85, s69, 21760
    buffer_load_dwordx4 v5, s[24:27], s85 offen lds
    s_add_u32 m0, s70, 20480
    s_add_u32 s85, s69, 28928
    buffer_load_dwordx4 v4, s[24:27], s85 offen lds
    s_waitcnt lgkmcnt(0)
    s_waitcnt vmcnt(10)
    s_barrier
    ds_read_b64_tr_b16 v[54:55], v10 offset:20480
    ds_read_b64_tr_b16 v[56:57], v10 offset:20736
    ds_read_b64_tr_b16 v[58:59], v11 offset:20480
    ds_read_b64_tr_b16 v[60:61], v11 offset:20992
    ds_read_b64_tr_b16 v[62:63], v12 offset:20480
    ds_read_b64_tr_b16 v[64:65], v12 offset:20992
    ds_read_b64_tr_b16 v[66:67], v13 offset:20480
    ds_read_b64_tr_b16 v[68:69], v13 offset:20992
    ds_read_b64_tr_b16 v[70:71], v14 offset:20480
    ds_read_b64_tr_b16 v[72:73], v14 offset:20992
    s_add_u32 m0, s70, 21504
    s_add_u32 s85, s69, 36096
    buffer_load_dwordx4 v5, s[24:27], s85 offen lds
    s_add_u32 m0, s70, 22528
    s_add_u32 s85, s69, 43264
    buffer_load_dwordx4 v4, s[24:27], s85 offen lds
    s_add_u32 m0, s70, 23552
    s_add_u32 s85, s69, 50432
    buffer_load_dwordx4 v5, s[24:27], s85 offen lds
    s_add_u32 m0, s71, 16384
    s_mov_b32 s85, 516096
    buffer_load_dwordx4 v6, s[48:51], s85 offen lds
    s_add_u32 m0, s87, 0
    s_mov_b32 s85, 688128
    buffer_load_dwordx4 v7, s[32:35], s85 offen lds
    s_add_u32 m0, s87, 8192
    s_mov_b32 s85, 688128
    buffer_load_dwordx4 v8, s[36:39], s85 offen lds
    s_add_u32 m0, s87, 1024
    s_mov_b32 s85, 716800
    buffer_load_dwordx4 v7, s[32:35], s85 offen lds
    s_add_u32 m0, s87, 9216
    s_mov_b32 s85, 716800
    buffer_load_dwordx4 v8, s[36:39], s85 offen lds
    s_add_u32 m0, s70, 0
    s_add_u32 s85, s69, 384
    buffer_load_dwordx4 v4, s[24:27], s85 offen lds
    s_add_u32 m0, s70, 1024
    s_add_u32 s85, s69, 7552
    buffer_load_dwordx4 v5, s[24:27], s85 offen lds
    s_add_u32 m0, s70, 2048
    s_add_u32 s85, s69, 14720
    buffer_load_dwordx4 v4, s[24:27], s85 offen lds
    s_add_u32 m0, s70, 3072
    s_add_u32 s85, s69, 21888
    buffer_load_dwordx4 v5, s[24:27], s85 offen lds
    s_add_u32 m0, s70, 12288
    s_add_u32 s85, s69, 29056
    buffer_load_dwordx4 v4, s[24:27], s85 offen lds
    s_mov_b32 s60, s8
    s_mov_b32 s61, s9
    s_mov_b32 s62, 25088
    s_mov_b32 s63, 0x20000
    s_mov_b32 s56, s18
    s_mov_b32 s57, s19
    s_mov_b32 s58, 1605632
    s_mov_b32 s59, 0x20000
    s_and_b32 s76, s2, 7
    v_readlane_b32 s98, v17, s76
    s_mov_b32 s77, 0
    s_cmp_eq_u32 s3, 8
    s_cselect_b32 s98, s98, 1
    s_cmp_lg_u32 s98, 0
    s_cbranch_scc1 K_hq_tok
K_hq_tokl:
    s_sleep 16
    buffer_load_dword v17, v16, s[44:47], 0 offen sc1
    s_waitcnt vmcnt(0)
    s_waitcnt vmcnt(0)
    v_readlane_b32 s98, v17, s76
    s_add_u32 s77, s77, 1
    s_nop 0
    s_cmp_lg_u32 s98, 0
    s_cbranch_scc1 K_hq_tok
    s_cmp_lt_u32 s77, 0x4000
    s_cbranch_scc1 K_hq_tokl
K_hq_tok:
    v_lshrrev_b32 v164, 2, v16
    v_add_u32 v164, 162112, v164
    ds_read_b64 v[164:165], v164
    v_mov_b32 v166, s98
    v_mov_b32 v167, 0
    s_and_b32 s74, s86, 0xfffffff8
    s_lshl_b32 s74, s74, 4
    s_add_u32 s74, s74, 12582912
    s_cmp_eq_u32 s3, 8
    s_cselect_b32 s74, s74, 0x40000000
    s_mov_b64 exec, 0xff
    s_waitcnt lgkmcnt(0)
    buffer_store_dwordx4 v[164:167], v2, s[40:43], s74 offen sc1
    s_mov_b64 exec, -1
    s_waitcnt vmcnt(11)
    s_barrier
    s_add_u32 m0, s70, 13312
    s_add_u32 s85, s69, 36224
    buffer_load_dwordx4 v5, s[24:27], s85 offen lds
    s_add_u32 m0, s70, 14336
    s_add_u32 s85, s69, 43392
    buffer_load_dwordx4 v4, s[24:27], s85 offen lds
    s_add_u32 m0, s70, 15360
    s_add_u32 s85, s69, 50560
    buffer_load_dwordx4 v5, s[24:27], s85 offen lds
    s_add_u32 m0, s71, 36864
    s_mov_b32 s85, 688128
    buffer_load_dwordx4 v6, s[48:51], s85 offen lds
    s_add_u32 m0, s87, 20480
    s_mov_b32 s85, 917504
    buffer_load_dwordx4 v7, s[32:35], s85 offen lds
    s_add_u32 m0, s87, 28672
    s_mov_b32 s85, 917504
    buffer_load_dwordx4 v8, s[36:39], s85 offen lds
    s_add_u32 m0, s87, 21504
    s_mov_b32 s85, 946176
    buffer_load_dwordx4 v7, s[32:35], s85 offen lds
    s_add_u32 m0, s87, 29696
    s_mov_b32 s85, 946176
    buffer_load_dwordx4 v8, s[36:39], s85 offen lds
    s_add_u32 m0, s70, 4096
    s_add_u32 s85, s69, 512
    buffer_load_dwordx4 v4, s[24:27], s85 offen lds
    s_add_u32 m0, s70, 5120
    s_add_u32 s85, s69, 7680
    buffer_load_dwordx4 v5, s[24:27], s85 offen lds
    s_add_u32 m0, s70, 6144
    s_add_u32 s85, s69, 14848
    buffer_load_dwordx4 v4, s[24:27], s85 offen lds
    s_add_u32 m0, s70, 7168
    s_add_u32 s85, s69, 22016
    buffer_load_dwordx4 v5, s[24:27], s85 offen lds
    s_add_u32 m0, s70, 16384
    s_add_u32 s85, s69, 29184
    buffer_load_dwordx4 v4, s[24:27], s85 offen lds
    s_add_u32 m0, s70, 17408
    s_add_u32 s85, s69, 36352
    buffer_load_dwordx4 v5, s[24:27], s85 offen lds
    ds_read_b64_tr_b16 v[74:75], v10 offset:40960
    ds_read_b64_tr_b16 v[76:77], v10 offset:41216
    ds_read_b64_tr_b16 v[78:79], v11 offset:40960
    ds_read_b64_tr_b16 v[80:81], v11 offset:41472
    ds_read_b64_tr_b16 v[82:83], v12 offset:40960
    ds_read_b64_tr_b16 v[84:85], v12 offset:41472
    ds_read_b64_tr_b16 v[86:87], v13 offset:40960
    ds_read_b64_tr_b16 v[88:89], v13 offset:41472
    ds_read_b64_tr_b16 v[90:91], v14 offset:40960
    ds_read_b64_tr_b16 v[92:93], v14 offset:41472
    v_mfma_f32_4x4x4_16b_bf16 v[140:143], v[134:135], v[34:35], v[140:143]
    v_mfma_f32_4x4x4_16b_bf16 v[144:147], v[134:135], v[38:39], v[144:147]
    v_mfma_f32_4x4x4_16b_bf16 v[148:151], v[134:135], v[42:43], v[148:151]
    v_mfma_f32_4x4x4_16b_bf16 v[152:155], v[134:135], v[46:47], v[152:155]
    v_mfma_f32_4x4x4_16b_bf16 v[156:159], v[134:135], v[50:51], v[156:159]
    v_mfma_f32_4x4x4_16b_bf16 v[140:143], v[134:135], v[36:37], v[140:143]
    v_mfma_f32_4x4x4_16b_bf16 v[144:147], v[134:135], v[40:41], v[144:147]
    v_mfma_f32_4x4x4_16b_bf16 v[148:151], v[134:135], v[44:45], v[148:151]
    v_mfma_f32_4x4x4_16b_bf16 v[152:155], v[134:135], v[48:49], v[152:155]
    v_mfma_f32_4x4x4_16b_bf16 v[156:159], v[134:135], v[52:53], v[156:159]
    s_waitcnt lgkmcnt(0)
    s_waitcnt vmcnt(11)
    s_barrier
    s_add_u32 m0, s70, 18432
    s_add_u32 s85, s69, 43520
    buffer_load_dwordx4 v4, s[24:27], s85 offen lds
    s_add_u32 m0, s70, 19456
    s_add_u32 s85, s69, 50688
    buffer_load_dwordx4 v5, s[24:27], s85 offen lds
    s_add_u32 m0, s71, 57344
    s_mov_b32 s85, 860160
    buffer_load_dwordx4 v6, s[48:51], s85 offen lds
    s_add_u32 m0, s87, 40960
    s_mov_b32 s85, 1146880
    buffer_load_dwordx4 v7, s[32:35], s85 offen lds
    s_add_u32 m0, s87, 49152
    s_mov_b32 s85, 1146880
    buffer_load_dwordx4 v8, s[36:39], s85 offen lds
    s_add_u32 m0, s87, 41984
    s_mov_b32 s85, 1175552
    buffer_load_dwordx4 v7, s[32:35], s85 offen lds
    s_add_u32 m0, s87, 50176
    s_mov_b32 s85, 1175552
    buffer_load_dwordx4 v8, s[36:39], s85 offen lds
    s_add_u32 m0, s70, 8192
    s_add_u32 s85, s69, 640
    buffer_load_dwordx4 v4, s[24:27], s85 offen lds
    s_add_u32 m0, s70, 9216
    s_add_u32 s85, s69, 7808
    buffer_load_dwordx4 v5, s[24:27], s85 offen lds
    s_add_u32 m0, s70, 10240
    s_add_u32 s85, s69, 14976
    buffer_load_dwordx4 v4, s[24:27], s85 offen lds
    s_add_u32 m0, s70, 11264
    s_add_u32 s85, s69, 22144
    buffer_load_dwordx4 v5, s[24:27], s85 offen lds
    s_add_u32 m0, s70, 20480
    s_add_u32 s85, s69, 29312
    buffer_load_dwordx4 v4, s[24:27], s85 offen lds
    s_add_u32 m0, s70, 21504
    s_add_u32 s85, s69, 36480
    buffer_load_dwordx4 v5, s[24:27], s85 offen lds
    s_add_u32 m0, s70, 22528
    s_add_u32 s85, s69, 43648
    buffer_load_dwordx4 v4, s[24:27], s85 offen lds
    ds_read_b64_tr_b16 v[94:95], v10 offset:0
    ds_read_b64_tr_b16 v[96:97], v10 offset:256
    ds_read_b64_tr_b16 v[98:99], v11 offset:0
    ds_read_b64_tr_b16 v[100:101], v11 offset:512
    ds_read_b64_tr_b16 v[102:103], v12 offset:0
    ds_read_b64_tr_b16 v[104:105], v12 offset:512
    ds_read_b64_tr_b16 v[106:107], v13 offset:0
    ds_read_b64_tr_b16 v[108:109], v13 offset:512
    ds_read_b64_tr_b16 v[110:111], v14 offset:0
    ds_read_b64_tr_b16 v[112:113], v14 offset:512
    v_mfma_f32_4x4x4_16b_bf16 v[140:143], v[134:135], v[54:55], v[140:143]
    v_mfma_f32_4x4x4_16b_bf16 v[144:147], v[134:135], v[58:59], v[144:147]
    v_mfma_f32_4x4x4_16b_bf16 v[148:151], v[134:135], v[62:63], v[148:151]
    v_mfma_f32_4x4x4_16b_bf16 v[152:155], v[134:135], v[66:67], v[152:155]
    v_mfma_f32_4x4x4_16b_bf16 v[156:159], v[134:135], v[70:71], v[156:159]
    v_mfma_f32_4x4x4_16b_bf16 v[140:143], v[134:135], v[56:57], v[140:143]
    v_mfma_f32_4x4x4_16b_bf16 v[144:147], v[134:135], v[60:61], v[144:147]
    v_mfma_f32_4x4x4_16b_bf16 v[148:151], v[134:135], v[64:65], v[148:151]
    v_mfma_f32_4x4x4_16b_bf16 v[152:155], v[134:135], v[68:69], v[152:155]
    v_mfma_f32_4x4x4_16b_bf16 v[156:159], v[134:135], v[72:73], v[156:159]
    s_waitcnt lgkmcnt(0)
    s_waitcnt vmcnt(12)
    s_barrier
    s_add_u32 m0, s70, 23552
    s_add_u32 s85, s69, 50816
    buffer_load_dwordx4 v5, s[24:27], s85 offen lds
    s_add_u32 m0, s71, 16384
    s_mov_b32 s85, 1032192
    buffer_load_dwordx4 v6, s[48:51], s85 offen lds
    s_add_u32 m0, s87, 0
    s_mov_b32 s85, 1376256
    buffer_load_dwordx4 v7, s[32:35], s85 offen lds
    s_add_u32 m0, s87, 8192
    s_mov_b32 s85, 1376256
    buffer_load_dwordx4 v8, s[36:39], s85 offen lds
    s_add_u32 m0, s87, 1024
    s_mov_b32 s85, 1404928
    buffer_load_dwordx4 v7, s[32:35], s85 offen lds
    s_add_u32 m0, s87, 9216
    s_mov_b32 s85, 1404928
    buffer_load_dwordx4 v8, s[36:39], s85 offen lds
    s_add_u32 m0, s70, 0
    s_add_u32 s85, s69, 768
    buffer_load_dwordx4 v4, s[24:27], s85 offen lds
    s_add_u32 m0, s70, 1024
    s_add_u32 s85, s69, 7936
    buffer_load_dwordx4 v5, s[24:27], s85 offen lds
    s_add_u32 m0, s70, 2048
    s_add_u32 s85, s69, 15104
    buffer_load_dwordx4 v4, s[24:27], s85 offen lds
    s_add_u32 m0, s70, 3072
    s_add_u32 s85, s69, 22272
    buffer_load_dwordx4 v5, s[24:27], s85 offen lds
    s_add_u32 m0, s70, 12288
    s_add_u32 s85, s69, 29440
    buffer_load_dwordx4 v4, s[24:27], s85 offen lds
    s_add_u32 m0, s70, 13312
    s_add_u32 s85, s69, 36608
    buffer_load_dwordx4 v5, s[24:27], s85 offen lds
    s_add_u32 m0, s70, 14336
    s_add_u32 s85, s69, 43776
    buffer_load_dwordx4 v4, s[24:27], s85 offen lds
    s_add_u32 m0, s70, 15360
    s_add_u32 s85, s69, 50944
    buffer_load_dwordx4 v5, s[24:27], s85 offen lds
    v_mov_b32 v160, -1
    v_mov_b32 v161, -1
    v_mov_b32 v162, -1
    v_mov_b32 v163, -1
    s_lshl_b32 s74, s64, 2
    s_add_u32 s74, s74, s72
    s_mul_i32 s74, s74, 294912
    s_lshl_b32 s75, s67, 11
    s_add_u32 s74, s74, s75
    s_add_u32 s74, s74, 114688
    s_add_u32 s75, s74, 147456
    buffer_store_dwordx4 v[160:163], v2, s[40:43], s74 offen offset:0 sc1
    buffer_store_dwordx4 v[160:163], v2, s[40:43], s74 offen offset:1024 sc1
    buffer_store_dwordx4 v[160:163], v2, s[40:43], s75 offen offset:0 sc1
    buffer_store_dwordx4 v[160:163], v2, s[40:43], s75 offen offset:1024 sc1
    ds_read_b64_tr_b16 v[114:115], v10 offset:20480
    ds_read_b64_tr_b16 v[116:117], v10 offset:20736
    ds_read_b64_tr_b16 v[118:119], v11 offset:20480
    ds_read_b64_tr_b16 v[120:121], v11 offset:20992
    ds_read_b64_tr_b16 v[122:123], v12 offset:20480
    ds_read_b64_tr_b16 v[124:125], v12 offset:20992
    ds_read_b64_tr_b16 v[126:127], v13 offset:20480
    ds_read_b64_tr_b16 v[128:129], v13 offset:20992
    ds_read_b64_tr_b16 v[130:131], v14 offset:20480
    ds_read_b64_tr_b16 v[132:133], v14 offset:20992
    v_mfma_f32_4x4x4_16b_bf16 v[140:143], v[134:135], v[74:75], v[140:143]
    v_mfma_f32_4x4x4_16b_bf16 v[144:147], v[134:135], v[78:79], v[144:147]
    v_mfma_f32_4x4x4_16b_bf16 v[148:151], v[134:135], v[82:83], v[148:151]
    v_mfma_f32_4x4x4_16b_bf16 v[152:155], v[134:135], v[86:87], v[152:155]
    v_mfma_f32_4x4x4_16b_bf16 v[156:159], v[134:135], v[90:91], v[156:159]
    v_mfma_f32_4x4x4_16b_bf16 v[140:143], v[134:135], v[76:77], v[140:143]
    v_mfma_f32_4x4x4_16b_bf16 v[144:147], v[134:135], v[80:81], v[144:147]
    v_mfma_f32_4x4x4_16b_bf16 v[148:151], v[134:135], v[84:85], v[148:151]
    v_mfma_f32_4x4x4_16b_bf16 v[152:155], v[134:135], v[88:89], v[152:155]
    v_mfma_f32_4x4x4_16b_bf16 v[156:159], v[134:135], v[92:93], v[156:159]
    s_waitcnt lgkmcnt(0)
    s_waitcnt vmcnt(17)
    s_barrier
    s_waitcnt vmcnt(0)
    s_lshl_b32 s99, s64, 2
    s_add_u32 s99, s99, s72
    s_lshl_b32 s99, s99, 10
    s_add_u32 s99, s99, 12582912
    buffer_load_dwordx3 v[160:162], v2, s[40:43], s99 offen sc1
    v_lshrrev_b32 v164, 4, v1
    s_lshl_b32 s74, s72, 3
    s_add_u32 s74, s74, 0
    v_add_u32 v164, s74, v164
    v_bfe_u32 v165, v1, 3, 1
    v_and_b32 v166, 7, v1
    v_mad_u32_u24 v165, v165, 7, v166
    v_mad_u32_u24 v165, v164, 14, v165
    v_lshlrev_b32 v165, 2, v165
    v_cmp_eq_u32_e64 s[88:89], 7, v166
    s_cmp_eq_u32 s74, 28
    s_cselect_b64 s[88:89], -1, s[88:89]
    v_mov_b32 v166, 0x7fffff00
    v_cndmask_b32_e64 v165, v165, v166, s[88:89]
    s_mul_i32 s75, s67, 1568
    s_lshl_b32 s74, s74, 6
    s_add_u32 m0, s74, 159744
    s_nop 0
    buffer_load_dword v165, s[60:63], s75 offen lds
    v_lshrrev_b32 v164, 4, v1
    s_lshl_b32 s74, s72, 3
    s_add_u32 s74, s74, 4
    v_add_u32 v164, s74, v164
    v_bfe_u32 v165, v1, 3, 1
    v_and_b32 v166, 7, v1
    v_mad_u32_u24 v165, v165, 7, v166
    v_mad_u32_u24 v165, v164, 14, v165
    v_lshlrev_b32 v165, 2, v165
    v_cmp_eq_u32_e64 s[88:89], 7, v166
    s_cmp_eq_u32 s74, 28
    s_cselect_b64 s[88:89], -1, s[88:89]
    v_mov_b32 v166, 0x7fffff00
    v_cndmask_b32_e64 v165, v165, v166, s[88:89]
    s_mul_i32 s75, s67, 1568
    s_lshl_b32 s74, s74, 6
    s_add_u32 m0, s74, 159744
    s_nop 0
    buffer_load_dword v165, s[60:63], s75 offen lds
    ds_read_b64_tr_b16 v[34:35], v10 offset:40960
    ds_read_b64_tr_b16 v[36:37], v10 offset:41216
    ds_read_b64_tr_b16 v[38:39], v11 offset:40960
    ds_read_b64_tr_b16 v[40:41], v11 offset:41472
    ds_read_b64_tr_b16 v[42:43], v12 offset:40960
    ds_read_b64_tr_b16 v[44:45], v12 offset:41472
    ds_read_b64_tr_b16 v[46:47], v13 offset:40960
    ds_read_b64_tr_b16 v[48:49], v13 offset:41472
    ds_read_b64_tr_b16 v[50:51], v14 offset:40960
    ds_read_b64_tr_b16 v[52:53], v14 offset:41472
    v_mfma_f32_4x4x4_16b_bf16 v[140:143], v[134:135], v[94:95], v[140:143]
    v_mfma_f32_4x4x4_16b_bf16 v[144:147], v[134:135], v[98:99], v[144:147]
    v_mfma_f32_4x4x4_16b_bf16 v[148:151], v[134:135], v[102:103], v[148:151]
    v_mfma_f32_4x4x4_16b_bf16 v[152:155], v[134:135], v[106:107], v[152:155]
    v_mfma_f32_4x4x4_16b_bf16 v[156:159], v[134:135], v[110:111], v[156:159]
    v_mfma_f32_4x4x4_16b_bf16 v[140:143], v[134:135], v[96:97], v[140:143]
    v_mfma_f32_4x4x4_16b_bf16 v[144:147], v[134:135], v[100:101], v[144:147]
    v_mfma_f32_4x4x4_16b_bf16 v[148:151], v[134:135], v[104:105], v[148:151]
    v_mfma_f32_4x4x4_16b_bf16 v[152:155], v[134:135], v[108:109], v[152:155]
    v_mfma_f32_4x4x4_16b_bf16 v[156:159], v[134:135], v[112:113], v[156:159]
    v_mfma_f32_4x4x4_16b_bf16 v[140:143], v[134:135], v[114:115], v[140:143]
    v_mfma_f32_4x4x4_16b_bf16 v[144:147], v[134:135], v[118:119], v[144:147]
    v_mfma_f32_4x4x4_16b_bf16 v[148:151], v[134:135], v[122:123], v[148:151]
    v_mfma_f32_4x4x4_16b_bf16 v[152:155], v[134:135], v[126:127], v[152:155]
    v_mfma_f32_4x4x4_16b_bf16 v[156:159], v[134:135], v[130:131], v[156:159]
    v_mfma_f32_4x4x4_16b_bf16 v[140:143], v[134:135], v[116:117], v[140:143]
    v_mfma_f32_4x4x4_16b_bf16 v[144:147], v[134:135], v[120:121], v[144:147]
    v_mfma_f32_4x4x4_16b_bf16 v[148:151], v[134:135], v[124:125], v[148:151]
    v_mfma_f32_4x4x4_16b_bf16 v[152:155], v[134:135], v[128:129], v[152:155]
    v_mfma_f32_4x4x4_16b_bf16 v[156:159], v[134:135], v[132:133], v[156:159]
    s_cmp_lg_u32 s3, 8
    s_cbranch_scc1 K_hq_tk2_ok
    v_and_b32 v16, 7, v1
    v_lshlrev_b32 v16, 5, v16
    s_mov_b32 s77, 0
K_hq_tk2_loop:
    buffer_load_dword v17, v16, s[44:47], 0 offen sc1
K_hq_tk2_chk:
    s_waitcnt vmcnt(0)
    s_add_u32 s77, s77, 1
    s_waitcnt vmcnt(0)
    v_cmp_eq_u32_e64 s[88:89], 0, v17
    s_nop 0
    s_cmp_eq_u64 s[88:89], 0
    s_cbranch_scc1 K_hq_tk2_wr
    s_sleep 16
    s_cmp_lt_u32 s77, 0x4000
    s_cbranch_scc1 K_hq_tk2_loop
K_hq_tk2_wr:
    v_lshrrev_b32 v16, 3, v16
    v_add_u32 v16, 162048, v16
    s_waitcnt vmcnt(0)
    ds_write_b32 v16, v17
K_hq_tk2_ok:
    s_waitcnt lgkmcnt(0)
    s_barrier
    s_lshl_b32 s74, s72, 1
    s_lshr_b32 s75, s64, 2
    s_add_u32 s74, s74, s75
    s_lshl_b32 s74, s74, 2
    s_add_u32 s74, s74, 162048
    v_mov_b32 v163, s74
    ds_read_b32 v163, v163
    s_waitcnt lgkmcnt(0)
    v_readfirstlane_b32 s78, v163
    s_waitcnt vmcnt(2)
    s_nop 0
    v_cmp_ne_u32_e64 s[88:89], s78, v162
    s_mov_b32 s77, 0
    s_cmp_eq_u64 s[88:89], 0
    s_cbranch_scc1 K_hq_stok
K_hq_st:
    s_sleep 8
    buffer_load_dwordx3 v[160:162], v2, s[40:43], s99 offen sc1
    s_waitcnt vmcnt(0)
    s_waitcnt vmcnt(0)
    v_cmp_ne_u32_e64 s[88:89], s78, v162
    s_add_u32 s77, s77, 1
    s_nop 0
    s_cmp_eq_u64 s[88:89], 0
    s_cbranch_scc1 K_hq_stok
    s_cmp_lt_u32 s77, 0x8000
    s_cbranch_scc1 K_hq_st
K_hq_stok:
    v_lshlrev_b32 v163, 3, v1
    s_lshl_b32 s74, s72, 9
    s_add_u32 s74, s74, 156672
    v_add_u32 v163, s74, v163
    ds_write_b64 v163, v[160:161]
    s_lshr_b32 s74, s2, 3
    s_lshl_b32 s74, s74, 2
    s_add_u32 s74, s74, s72
    s_lshl_b32 s74, s74, 14
    s_mov_b32 s77, 1605632
    s_cmp_lt_u32 s74, s77
    s_cselect_b32 s12, s18, s10
    s_cselect_b32 s13, s19, s11
    s_cselect_b32 s14, s77, 401408
    s_mov_b32 s15, 0x20000
    s_cselect_b32 s77, 0, s77
    s_sub_u32 s74, s74, s77
    v_lshlrev_b32 v16, 7, v1
    s_add_u32 s75, s74, 0x2000
    buffer_load_dword v163, v16, s[12:15], s74 offen
    buffer_load_dword v164, v16, s[12:15], s75 offen
    ds_read_b64_tr_b16 v[54:55], v10 offset:0
    ds_read_b64_tr_b16 v[56:57], v10 offset:256
    ds_read_b64_tr_b16 v[58:59], v11 offset:0
    ds_read_b64_tr_b16 v[60:61], v11 offset:512
    ds_read_b64_tr_b16 v[62:63], v12 offset:0
    ds_read_b64_tr_b16 v[64:65], v12 offset:512
    ds_read_b64_tr_b16 v[66:67], v13 offset:0
    ds_read_b64_tr_b16 v[68:69], v13 offset:512
    ds_read_b64_tr_b16 v[70:71], v14 offset:0
    ds_read_b64_tr_b16 v[72:73], v14 offset:512
    v_mfma_f32_4x4x4_16b_bf16 v[140:143], v[134:135], v[34:35], v[140:143]
    v_mfma_f32_4x4x4_16b_bf16 v[144:147], v[134:135], v[38:39], v[144:147]
    v_mfma_f32_4x4x4_16b_bf16 v[148:151], v[134:135], v[42:43], v[148:151]
    v_mfma_f32_4x4x4_16b_bf16 v[152:155], v[134:135], v[46:47], v[152:155]
    v_mfma_f32_4x4x4_16b_bf16 v[156:159], v[134:135], v[50:51], v[156:159]
    v_mfma_f32_4x4x4_16b_bf16 v[140:143], v[134:135], v[36:37], v[140:143]
    v_mfma_f32_4x4x4_16b_bf16 v[144:147], v[134:135], v[40:41], v[144:147]
    v_mfma_f32_4x4x4_16b_bf16 v[148:151], v[134:135], v[44:45], v[148:151]
    v_mfma_f32_4x4x4_16b_bf16 v[152:155], v[134:135], v[48:49], v[152:155]
    v_mfma_f32_4x4x4_16b_bf16 v[156:159], v[134:135], v[52:53], v[156:159]
    s_waitcnt lgkmcnt(9)
    v_mfma_f32_4x4x4_16b_bf16 v[140:143], v[134:135], v[54:55], v[140:143]
    s_waitcnt lgkmcnt(7)
    v_mfma_f32_4x4x4_16b_bf16 v[144:147], v[134:135], v[58:59], v[144:147]
    s_waitcnt lgkmcnt(5)
    v_mfma_f32_4x4x4_16b_bf16 v[148:151], v[134:135], v[62:63], v[148:151]
    s_waitcnt lgkmcnt(3)
    v_mfma_f32_4x4x4_16b_bf16 v[152:155], v[134:135], v[66:67], v[152:155]
    s_waitcnt lgkmcnt(1)
    v_mfma_f32_4x4x4_16b_bf16 v[156:159], v[134:135], v[70:71], v[156:159]
    v_mfma_f32_4x4x4_16b_bf16 v[140:143], v[134:135], v[56:57], v[140:143]
    v_mfma_f32_4x4x4_16b_bf16 v[144:147], v[134:135], v[60:61], v[144:147]
    v_mfma_f32_4x4x4_16b_bf16 v[148:151], v[134:135], v[64:65], v[148:151]
    v_mfma_f32_4x4x4_16b_bf16 v[152:155], v[134:135], v[68:69], v[152:155]
    s_waitcnt lgkmcnt(0)
    v_mfma_f32_4x4x4_16b_bf16 v[156:159], v[134:135], v[72:73], v[156:159]
    s_nop 2
    v_mov_b32 v18, v140
    v_mov_b32 v19, v144
    v_mov_b32 v20, v148
    v_mov_b32 v21, v152
    s_nop 0
    v_mov_b32 v22, v156
    s_lshl_b32 s74, s72, 2
    s_add_u32 s74, s74, 147456
    v_add_u32 v136, s74, v2
    v_cvt_pk_bf16_f32 v137, v18, v18
    v_cvt_pk_bf16_f32 v138, v19, v19
    v_cvt_pk_bf16_f32 v139, v20, v20
    v_cvt_pk_bf16_f32 v140, v21, v21
    v_cvt_pk_bf16_f32 v141, v22, v22
    v_lshlrev_b32 v137, 16, v137
    v_lshlrev_b32 v138, 16, v138
    v_lshlrev_b32 v139, 16, v139
    v_lshlrev_b32 v140, 16, v140
    v_lshlrev_b32 v141, 16, v141
    v_sub_f32 v137, v18, v137
    v_sub_f32 v138, v19, v138
    v_sub_f32 v139, v20, v139
    v_sub_f32 v140, v21, v140
    v_sub_f32 v141, v22, v141
    v_cvt_pk_bf16_f32 v137, v18, v137
    v_cvt_pk_bf16_f32 v138, v19, v138
    v_cvt_pk_bf16_f32 v139, v20, v139
    v_cvt_pk_bf16_f32 v140, v21, v140
    v_cvt_pk_bf16_f32 v141, v22, v141
    ds_write_b32 v136, v137 offset:0
    ds_write_b32 v136, v138 offset:1024
    ds_write_b32 v136, v139 offset:2048
    ds_write_b32 v136, v140 offset:3072
    ds_write_b32 v136, v141 offset:4096
    s_waitcnt vmcnt(2)
    s_waitcnt lgkmcnt(0)
K_hpost_q:
    s_and_b32 s74, s2, 7
    s_lshr_b32 s75, s2, 3
    s_and_b32 s76, s74, 1
    s_lshl_b32 s76, s76, 2
    s_lshr_b32 s74, s74, 1
    s_add_u32 s73, s74, s76
    s_lshl_b32 s65, s73, 2
    s_and_b32 s76, s75, 3
    s_add_u32 s65, s65, s76
    s_lshr_b32 s66, s75, 2
    v_lshrrev_b32 v60, 3, v1
    v_and_b32 v61, 7, v1
    v_bfe_u32 v62, v1, 4, 1
    v_lshlrev_b32 v62, 2, v62
    v_xor_b32 v61, v61, v62
    s_lshl_b32 s74, s66, 7
    v_lshlrev_b32 v61, 4, v61
    v_add_u32 v61, s74, v61
    v_mul_u32_u24 v18, 896, v60
    v_add_u32 v18, v18, v61
    s_mul_i32 s70, s72, 36864
    s_and_b32 s74, s72, 1
    s_lshl_b32 s74, s74, 2
    s_lshr_b32 s75, s72, 1
    s_add_u32 s74, s74, s75
    s_mul_i32 s69, s74, 200704
    s_cmp_ge_u32 s2, 224
    s_cselect_b32 s74, 0x40000000, 0
    s_add_u32 s69, s69, s74
    s_lshl_b32 s74, s72, 11
    v_add_u32 v4, s74, v2
    v_and_b32 v8, 7, v1
    v_lshlrev_b32 v8, 13, v8
    v_add_u32 v8, 0x1e80, v8
    s_lshl_b32 s74, s72, 10
    s_add_u32 s74, s74, 152576
    v_add_u32 v5, s74, v2
    v_add_u32 v6, 152576, v2
    v_add_u32 v7, s70, v2
    s_lshl_b32 s74, s64, 2
    s_add_u32 s74, s74, s72
    s_mul_i32 s82, s74, 294912
    s_lshl_b32 s74, s67, 11
    s_add_u32 s82, s82, s74
    s_add_u32 s82, s82, 114688
    s_lshl_b32 s87, s67, 16
    s_add_u32 s87, s87, 11534336
    s_barrier
    s_setprio 0
    s_add_u32 m0, s70, 0
    s_add_u32 s85, s69, 0
    buffer_load_dwordx4 v18, s[56:59], s85 offen lds
    s_add_u32 m0, s70, 1024
    s_add_u32 s85, s69, 7168
    buffer_load_dwordx4 v18, s[56:59], s85 offen lds
    s_add_u32 m0, s70, 18432
    s_add_u32 s85, s69, 401408
    buffer_load_dwordx4 v18, s[56:59], s85 offen lds
    s_add_u32 m0, s70, 19456
    s_add_u32 s85, s69, 408576
    buffer_load_dwordx4 v18, s[56:59], s85 offen lds
    s_add_u32 m0, s70, 2048
    s_add_u32 s85, s69, 14336
    buffer_load_dwordx4 v18, s[56:59], s85 offen lds
    s_add_u32 m0, s70, 3072
    s_add_u32 s85, s69, 21504
    buffer_load_dwordx4 v18, s[56:59], s85 offen lds
    s_add_u32 m0, s70, 20480
    s_add_u32 s85, s69, 415744
    buffer_load_dwordx4 v18, s[56:59], s85 offen lds
    s_add_u32 m0, s70, 21504
    s_add_u32 s85, s69, 422912
    buffer_load_dwordx4 v18, s[56:59], s85 offen lds
    s_add_u32 m0, s70, 4096
    s_add_u32 s85, s69, 28672
    buffer_load_dwordx4 v18, s[56:59], s85 offen lds
    s_add_u32 m0, s70, 5120
    s_add_u32 s85, s69, 35840
    buffer_load_dwordx4 v18, s[56:59], s85 offen lds
    s_add_u32 m0, s70, 22528
    s_add_u32 s85, s69, 430080
    buffer_load_dwordx4 v18, s[56:59], s85 offen lds
    s_add_u32 m0, s70, 23552
    s_add_u32 s85, s69, 437248
    buffer_load_dwordx4 v18, s[56:59], s85 offen lds
    s_add_u32 m0, s70, 6144
    s_add_u32 s85, s69, 43008
    buffer_load_dwordx4 v18, s[56:59], s85 offen lds
    s_add_u32 m0, s70, 7168
    s_add_u32 s85, s69, 50176
    buffer_load_dwordx4 v18, s[56:59], s85 offen lds
    s_add_u32 m0, s70, 24576
    s_add_u32 s85, s69, 444416
    buffer_load_dwordx4 v18, s[56:59], s85 offen lds
    s_add_u32 m0, s70, 25600
    s_add_u32 s85, s69, 451584
    buffer_load_dwordx4 v18, s[56:59], s85 offen lds
    s_add_u32 m0, s70, 8192
    s_add_u32 s85, s69, 57344
    buffer_load_dwordx4 v18, s[56:59], s85 offen lds
    s_add_u32 m0, s70, 9216
    s_add_u32 s85, s69, 64512
    buffer_load_dwordx4 v18, s[56:59], s85 offen lds
    s_add_u32 m0, s70, 26624
    s_add_u32 s85, s69, 458752
    buffer_load_dwordx4 v18, s[56:59], s85 offen lds
    s_add_u32 m0, s70, 27648
    s_add_u32 s85, s69, 465920
    buffer_load_dwordx4 v18, s[56:59], s85 offen lds
    s_add_u32 m0, s70, 10240
    s_add_u32 s85, s69, 71680
    buffer_load_dwordx4 v18, s[56:59], s85 offen lds
    s_add_u32 m0, s70, 11264
    s_add_u32 s85, s69, 78848
    buffer_load_dwordx4 v18, s[56:59], s85 offen lds
    s_add_u32 m0, s70, 28672
    s_add_u32 s85, s69, 473088
    buffer_load_dwordx4 v18, s[56:59], s85 offen lds
    s_add_u32 m0, s70, 29696
    s_add_u32 s85, s69, 480256
    buffer_load_dwordx4 v18, s[56:59], s85 offen lds
    s_waitcnt vmcnt(0)
    v_mov_b32 v12, 161812
    v_mov_b32 v13, 1
    s_mov_b64 exec, 1
    ds_add_u32 v12, v13
    s_mov_b64 exec, -1
    s_barrier
    ds_read_b128 v[100:103], v7 offset:12288
    ds_read_b128 v[104:107], v7 offset:13312
    ds_read_b128 v[108:111], v7 offset:14336
    ds_read_b128 v[112:115], v7 offset:15360
    ds_read_b128 v[116:119], v7 offset:30720
    ds_read_b128 v[120:123], v7 offset:31744
    ds_read_b128 v[124:127], v7 offset:32768
    ds_read_b128 v[128:131], v7 offset:33792
    s_waitcnt lgkmcnt(0)
    v_mov_b32 v12, 161804
    v_mov_b32 v13, 1
    s_mov_b64 exec, 1
    ds_add_u32 v12, v13
    s_mov_b64 exec, -1
    s_setprio 3
    v_mov_b32 v14, 161808
    s_cmp_lg_u32 s3, 8
    s_cbranch_scc1 K_hq_spin
    v_and_b32 v16, 7, v1
    v_lshrrev_b32 v17, 2, v16
    s_lshr_b32 s74, s67, 2
    s_lshl_b32 s74, s74, 3
    s_add_u32 s74, s74, 162048
    v_lshlrev_b32 v17, 2, v17
    v_add_u32 v17, s74, v17
    ds_read_b32 v17, v17
    v_lshlrev_b32 v16, 2, v16
    s_mul_i32 s76, s2, 4352
    s_add_u32 s76, s76, 14680192
    s_mov_b32 s77, 0
K_hq_kp:
    buffer_load_dword v15, v16, s[40:43], s76 offen sc1
    s_waitcnt vmcnt(0) lgkmcnt(0)
    s_waitcnt vmcnt(0) lgkmcnt(0)
    v_cmp_ne_u32_e64 s[88:89], v17, v15
    s_add_u32 s77, s77, 1
    s_nop 0
    s_cmp_eq_u64 s[88:89], 0
    s_cbranch_scc1 K_hq_kpok
    s_sleep 8
    s_cmp_lt_u32 s77, 0x8000
    s_cbranch_scc1 K_hq_kp
K_hq_kpok:
    s_mov_b32 s77, 0
K_hq_pkv_loop:
    s_waitcnt vmcnt(0)
    buffer_load_dword v15, v8, s[40:43], s87 offen sc1
    s_waitcnt vmcnt(0)
    s_waitcnt vmcnt(0)
    v_cmp_eq_u32_e64 s[88:89], -1, v15
    s_add_u32 s77, s77, 1
    s_nop 0
    s_cmp_eq_u64 s[88:89], 0
    s_cbranch_scc1 K_hq_pkv_ok
    s_sleep 8
    s_cmp_lt_u32 s77, 0x8000
    s_cbranch_scc1 K_hq_pkv_loop
K_hq_pkv_ok:
    ds_write_b32 v14, v13
    s_branch K_hq_go
K_hq_spin:
    s_sleep 2
    ds_read_b32 v13, v14
    s_waitcnt lgkmcnt(0)
    s_waitcnt lgkmcnt(0)
    v_readfirstlane_b32 s75, v13
    s_nop 0
    s_cmp_eq_u32 s75, 0
    s_cbranch_scc1 K_hq_spin
K_hq_go:
    s_mov_b32 s78, 0
K_hq_gather:
    s_mov_b32 s74, s87
    buffer_load_dwordx4 v[20:23], v4, s[40:43], s74 offen offset:0 sc1
    buffer_load_dwordx4 v[24:27], v4, s[40:43], s74 offen offset:1024 sc1
    s_add_u32 s74, s74, 8192
    buffer_load_dwordx4 v[28:31], v4, s[40:43], s74 offen offset:0 sc1
    buffer_load_dwordx4 v[32:35], v4, s[40:43], s74 offen offset:1024 sc1
    s_add_u32 s74, s74, 8192
    buffer_load_dwordx4 v[36:39], v4, s[40:43], s74 offen offset:0 sc1
    buffer_load_dwordx4 v[40:43], v4, s[40:43], s74 offen offset:1024 sc1
    s_add_u32 s74, s74, 8192
    buffer_load_dwordx4 v[44:47], v4, s[40:43], s74 offen offset:0 sc1
    buffer_load_dwordx4 v[48:51], v4, s[40:43], s74 offen offset:1024 sc1
    s_add_u32 s74, s74, 8192
    buffer_load_dwordx4 v[52:55], v4, s[40:43], s74 offen offset:0 sc1
    buffer_load_dwordx4 v[56:59], v4, s[40:43], s74 offen offset:1024 sc1
    s_add_u32 s74, s74, 8192
    buffer_load_dwordx4 v[60:63], v4, s[40:43], s74 offen offset:0 sc1
    buffer_load_dwordx4 v[64:67], v4, s[40:43], s74 offen offset:1024 sc1
    s_add_u32 s74, s74, 8192
    buffer_load_dwordx4 v[68:71], v4, s[40:43], s74 offen offset:0 sc1
    buffer_load_dwordx4 v[72:75], v4, s[40:43], s74 offen offset:1024 sc1
    s_add_u32 s74, s74, 8192
    buffer_load_dwordx4 v[76:79], v4, s[40:43], s74 offen offset:0 sc1
    buffer_load_dwordx4 v[80:83], v4, s[40:43], s74 offen offset:1024 sc1
    s_waitcnt vmcnt(15)
    v_max3_u32 v15, v20, v21, v22
    s_waitcnt vmcnt(14)
    v_max3_u32 v15, v15, v23, v24
    v_max3_u32 v15, v15, v25, v26
    s_waitcnt vmcnt(13)
    v_max3_u32 v15, v15, v27, v28
    v_max3_u32 v15, v15, v29, v30
    s_waitcnt vmcnt(12)
    v_max3_u32 v15, v15, v31, v32
    v_max3_u32 v15, v15, v33, v34
    s_waitcnt vmcnt(11)
    v_max3_u32 v15, v15, v35, v36
    v_max3_u32 v15, v15, v37, v38
    s_waitcnt vmcnt(10)
    v_max3_u32 v15, v15, v39, v40
    v_max3_u32 v15, v15, v41, v42
    s_waitcnt vmcnt(9)
    v_max3_u32 v15, v15, v43, v44
    v_max3_u32 v15, v15, v45, v46
    s_waitcnt vmcnt(8)
    v_max3_u32 v15, v15, v47, v48
    v_max3_u32 v15, v15, v49, v50
    s_waitcnt vmcnt(7)
    v_max3_u32 v15, v15, v51, v52
    v_max3_u32 v15, v15, v53, v54
    s_waitcnt vmcnt(6)
    v_max3_u32 v15, v15, v55, v56
    v_max3_u32 v15, v15, v57, v58
    s_waitcnt vmcnt(5)
    v_max3_u32 v15, v15, v59, v60
    v_max3_u32 v15, v15, v61, v62
    s_waitcnt vmcnt(4)
    v_max3_u32 v15, v15, v63, v64
    v_max3_u32 v15, v15, v65, v66
    s_waitcnt vmcnt(3)
    v_max3_u32 v15, v15, v67, v68
    v_max3_u32 v15, v15, v69, v70
    s_waitcnt vmcnt(2)
    v_max3_u32 v15, v15, v71, v72
    v_max3_u32 v15, v15, v73, v74
    s_waitcnt vmcnt(1)
    v_max3_u32 v15, v15, v75, v76
    v_max3_u32 v15, v15, v77, v78
    s_waitcnt vmcnt(0)
    v_max3_u32 v15, v15, v79, v80
    v_max3_u32 v15, v15, v81, v82
    v_max_u32 v15, v15, v83
    v_cmp_eq_u32_e64 s[88:89], -1, v15
    s_add_u32 s78, s78, 1
    s_cmp_eq_u64 s[88:89], 0
    s_cbranch_scc1 K_hq_gok
    s_cmp_lt_u32 s78, 0x1000
    s_cbranch_scc1 K_hq_gather
K_hq_gok:
    v_pk_add_f32 v[20:21], v[20:21], v[28:29]
    v_pk_add_f32 v[22:23], v[22:23], v[30:31]
    v_pk_add_f32 v[24:25], v[24:25], v[32:33]
    v_pk_add_f32 v[26:27], v[26:27], v[34:35]
    v_pk_add_f32 v[36:37], v[36:37], v[44:45]
    v_pk_add_f32 v[38:39], v[38:39], v[46:47]
    v_pk_add_f32 v[40:41], v[40:41], v[48:49]
    v_pk_add_f32 v[42:43], v[42:43], v[50:51]
    v_pk_add_f32 v[52:53], v[52:53], v[60:61]
    v_pk_add_f32 v[54:55], v[54:55], v[62:63]
    v_pk_add_f32 v[56:57], v[56:57], v[64:65]
    v_pk_add_f32 v[58:59], v[58:59], v[66:67]
    v_pk_add_f32 v[68:69], v[68:69], v[76:77]
    v_pk_add_f32 v[70:71], v[70:71], v[78:79]
    v_pk_add_f32 v[72:73], v[72:73], v[80:81]
    v_pk_add_f32 v[74:75], v[74:75], v[82:83]
    v_pk_add_f32 v[20:21], v[20:21], v[36:37]
    v_pk_add_f32 v[22:23], v[22:23], v[38:39]
    v_pk_add_f32 v[24:25], v[24:25], v[40:41]
    v_pk_add_f32 v[26:27], v[26:27], v[42:43]
    v_pk_add_f32 v[52:53], v[52:53], v[68:69]
    v_pk_add_f32 v[54:55], v[54:55], v[70:71]
    v_pk_add_f32 v[56:57], v[56:57], v[72:73]
    v_pk_add_f32 v[58:59], v[58:59], v[74:75]
    v_pk_add_f32 v[20:21], v[20:21], v[52:53]
    v_pk_add_f32 v[22:23], v[22:23], v[54:55]
    v_pk_add_f32 v[24:25], v[24:25], v[56:57]
    v_pk_add_f32 v[26:27], v[26:27], v[58:59]
    v_cvt_pk_bf16_f32 v28, v20, v21
    v_cvt_pk_bf16_f32 v29, v22, v23
    v_cvt_pk_bf16_f32 v30, v24, v25
    v_cvt_pk_bf16_f32 v31, v26, v27
    ds_write_b128 v5, v[28:31]
    s_waitcnt lgkmcnt(0)
    v_mov_b32 v12, 161792
    v_mov_b32 v13, 1
    s_mov_b64 exec, 1
    ds_add_u32 v12, v13
    s_mov_b64 exec, -1
K_hq_sync:
    ds_read_b32 v13, v12
    s_waitcnt lgkmcnt(0)
    v_readfirstlane_b32 s75, v13
    s_nop 0
    s_cmp_lt_u32 s75, 4
    s_cbranch_scc1 K_hq_sync
    ds_read_b128 v[20:23], v6 offset:0
    ds_read_b128 v[24:27], v6 offset:1024
    ds_read_b128 v[28:31], v6 offset:2048
    ds_read_b128 v[32:35], v6 offset:3072
    s_waitcnt lgkmcnt(3)
    v_mfma_f32_32x32x16_bf16 v[36:51], v[20:23], v[100:103], 0
    s_waitcnt lgkmcnt(2)
    v_mfma_f32_32x32x16_bf16 v[36:51], v[24:27], v[104:107], v[36:51]
    s_waitcnt lgkmcnt(1)
    v_mfma_f32_32x32x16_bf16 v[36:51], v[28:31], v[108:111], v[36:51]
    s_waitcnt lgkmcnt(0)
    v_mfma_f32_32x32x16_bf16 v[36:51], v[32:35], v[112:115], v[36:51]
    v_mfma_f32_32x32x16_bf16 v[52:67], v[20:23], v[116:119], 0
    v_mfma_f32_32x32x16_bf16 v[52:67], v[24:27], v[120:123], v[52:67]
    v_mfma_f32_32x32x16_bf16 v[52:67], v[28:31], v[124:127], v[52:67]
    v_mfma_f32_32x32x16_bf16 v[52:67], v[32:35], v[128:131], v[52:67]
    s_nop 7
    v_cvt_pk_bf16_f32 v68, v50, v50
    v_lshlrev_b32 v68, 16, v68
    v_add_f32 v68, 0x358637bd, v68
    v_cvt_pk_bf16_f32 v68, v68, v68
    v_lshlrev_b32 v68, 16, v68
    v_rcp_f32 v68, v68
    v_cvt_pk_bf16_f32 v69, v36, v37
    v_cvt_pk_bf16_f32 v70, v38, v39
    v_cvt_pk_bf16_f32 v71, v40, v41
    v_cvt_pk_bf16_f32 v72, v42, v43
    v_cvt_pk_bf16_f32 v73, v44, v45
    v_cvt_pk_bf16_f32 v74, v46, v47
    v_cvt_pk_bf16_f32 v75, v48, v49
    v_lshlrev_b32 v36, 16, v69
    v_and_b32 v37, 0xffff0000, v69
    v_lshlrev_b32 v38, 16, v70
    v_and_b32 v39, 0xffff0000, v70
    v_lshlrev_b32 v40, 16, v71
    v_and_b32 v41, 0xffff0000, v71
    v_lshlrev_b32 v42, 16, v72
    v_and_b32 v43, 0xffff0000, v72
    v_lshlrev_b32 v44, 16, v73
    v_and_b32 v45, 0xffff0000, v73
    v_lshlrev_b32 v46, 16, v74
    v_and_b32 v47, 0xffff0000, v74
    v_lshlrev_b32 v48, 16, v75
    v_and_b32 v49, 0xffff0000, v75
    v_pk_mul_f32 v[36:37], v[36:37], v[68:69] op_sel_hi:[1,0]
    v_pk_mul_f32 v[38:39], v[38:39], v[68:69] op_sel_hi:[1,0]
    v_pk_mul_f32 v[40:41], v[40:41], v[68:69] op_sel_hi:[1,0]
    v_pk_mul_f32 v[42:43], v[42:43], v[68:69] op_sel_hi:[1,0]
    v_pk_mul_f32 v[44:45], v[44:45], v[68:69] op_sel_hi:[1,0]
    v_pk_mul_f32 v[46:47], v[46:47], v[68:69] op_sel_hi:[1,0]
    v_pk_mul_f32 v[48:49], v[48:49], v[68:69] op_sel_hi:[1,0]
    v_cvt_pk_bf16_f32 v84, v36, v37
    v_cvt_pk_bf16_f32 v85, v38, v39
    v_cvt_pk_bf16_f32 v86, v40, v41
    v_cvt_pk_bf16_f32 v87, v42, v43
    v_cvt_pk_bf16_f32 v88, v44, v45
    v_cvt_pk_bf16_f32 v89, v46, v47
    v_cvt_pk_bf16_f32 v90, v48, v49
    v_mov_b32 v91, 0
    s_add_u32 s74, s82, 0
    buffer_store_dwordx4 v[84:87], v2, s[40:43], s74 offen sc1
    buffer_store_dwordx4 v[88:91], v2, s[40:43], s74 offen offset:1024 sc1
    v_cvt_pk_bf16_f32 v68, v66, v66
    v_lshlrev_b32 v68, 16, v68
    v_add_f32 v68, 0x358637bd, v68
    v_cvt_pk_bf16_f32 v68, v68, v68
    v_lshlrev_b32 v68, 16, v68
    v_rcp_f32 v68, v68
    v_cvt_pk_bf16_f32 v69, v52, v53
    v_cvt_pk_bf16_f32 v70, v54, v55
    v_cvt_pk_bf16_f32 v71, v56, v57
    v_cvt_pk_bf16_f32 v72, v58, v59
    v_cvt_pk_bf16_f32 v73, v60, v61
    v_cvt_pk_bf16_f32 v74, v62, v63
    v_cvt_pk_bf16_f32 v75, v64, v65
    v_lshlrev_b32 v52, 16, v69
    v_and_b32 v53, 0xffff0000, v69
    v_lshlrev_b32 v54, 16, v70
    v_and_b32 v55, 0xffff0000, v70
    v_lshlrev_b32 v56, 16, v71
    v_and_b32 v57, 0xffff0000, v71
    v_lshlrev_b32 v58, 16, v72
    v_and_b32 v59, 0xffff0000, v72
    v_lshlrev_b32 v60, 16, v73
    v_and_b32 v61, 0xffff0000, v73
    v_lshlrev_b32 v62, 16, v74
    v_and_b32 v63, 0xffff0000, v74
    v_lshlrev_b32 v64, 16, v75
    v_and_b32 v65, 0xffff0000, v75
    v_pk_mul_f32 v[52:53], v[52:53], v[68:69] op_sel_hi:[1,0]
    v_pk_mul_f32 v[54:55], v[54:55], v[68:69] op_sel_hi:[1,0]
    v_pk_mul_f32 v[56:57], v[56:57], v[68:69] op_sel_hi:[1,0]
    v_pk_mul_f32 v[58:59], v[58:59], v[68:69] op_sel_hi:[1,0]
    v_pk_mul_f32 v[60:61], v[60:61], v[68:69] op_sel_hi:[1,0]
    v_pk_mul_f32 v[62:63], v[62:63], v[68:69] op_sel_hi:[1,0]
    v_pk_mul_f32 v[64:65], v[64:65], v[68:69] op_sel_hi:[1,0]
    v_cvt_pk_bf16_f32 v92, v52, v53
    v_cvt_pk_bf16_f32 v93, v54, v55
    v_cvt_pk_bf16_f32 v94, v56, v57
    v_cvt_pk_bf16_f32 v95, v58, v59
    v_cvt_pk_bf16_f32 v96, v60, v61
    v_cvt_pk_bf16_f32 v97, v62, v63
    v_cvt_pk_bf16_f32 v98, v64, v65
    v_mov_b32 v99, 0
    s_add_u32 s74, s82, 147456
    buffer_store_dwordx4 v[92:95], v2, s[40:43], s74 offen sc1
    buffer_store_dwordx4 v[96:99], v2, s[40:43], s74 offen offset:1024 sc1
    s_endpgm
K_hkv:
    v_mul_u32_u24 v139, 3584, v136
    v_lshl_add_u32 v7, v137, 4, v139
    s_mul_i32 s85, s72, 57344
    s_add_u32 s85, s85, s84
    v_add_u32 v7, s85, v7
    v_xor_b32 v8, 32, v7
    s_lshr_b32 s76, s72, 1
    s_cmp_eq_u32 s76, 0
    s_cselect_b32 s52, s14, s16
    s_cselect_b32 s53, s15, s17
    s_mov_b32 s54, 1605632
    s_mov_b32 s55, 0x20000
    s_lshl_b32 s76, s76, 2
    v_lshrrev_b32 v141, 1, v1
    v_xor_b32 v141, s76, v141
    v_mul_u32_u24 v141, 3584, v141
    v_and_b32 v142, 1, v1
    v_lshl_add_u32 v141, v142, 4, v141
    s_and_b32 s76, s72, 1
    s_mul_i32 s76, s76, 114688
    s_add_u32 s76, s76, s83
    v_add_u32 v9, s76, v141
    s_lshl_b32 s71, s72, 10
    s_add_u32 s71, s71, 98304
    s_lshl_b32 s87, s72, 12
    s_add_u32 s87, s87, 98304
    s_add_u32 m0, s87, 0
    s_mov_b32 s85, 896
    buffer_load_dwordx4 v6, s[48:51], s85 offen lds
    s_add_u32 m0, s87, 1024
    s_mov_b32 s85, 1792
    buffer_load_dwordx4 v6, s[48:51], s85 offen lds
    s_add_u32 m0, s87, 2048
    s_mov_b32 s85, 0
    buffer_load_dwordx4 v7, s[32:35], s85 offen lds
    s_add_u32 m0, s87, 3072
    s_mov_b32 s85, 0
    buffer_load_dwordx4 v8, s[36:39], s85 offen lds
    s_add_u32 m0, s71, 16384
    s_mov_b32 s85, 0
    buffer_load_dwordx4 v9, s[52:55], s85 offen lds
    s_add_u32 m0, s70, 0
    s_add_u32 s85, s69, 0
    buffer_load_dwordx4 v4, s[24:27], s85 offen lds
    s_add_u32 m0, s70, 1024
    s_add_u32 s85, s69, 7168
    buffer_load_dwordx4 v5, s[24:27], s85 offen lds
    s_add_u32 m0, s70, 2048
    s_add_u32 s85, s69, 14336
    buffer_load_dwordx4 v4, s[24:27], s85 offen lds
    s_add_u32 m0, s70, 3072
    s_add_u32 s85, s69, 21504
    buffer_load_dwordx4 v5, s[24:27], s85 offen lds
    s_add_u32 m0, s70, 12288
    s_add_u32 s85, s69, 28672
    buffer_load_dwordx4 v4, s[24:27], s85 offen lds
    s_add_u32 m0, s70, 13312
    s_add_u32 s85, s69, 35840
    buffer_load_dwordx4 v5, s[24:27], s85 offen lds
    s_add_u32 m0, s70, 14336
    s_add_u32 s85, s69, 43008
    buffer_load_dwordx4 v4, s[24:27], s85 offen lds
    s_add_u32 m0, s70, 15360
    s_add_u32 s85, s69, 50176
    buffer_load_dwordx4 v5, s[24:27], s85 offen lds
    v_lshrrev_b32 v63, 5, v1
    v_bfe_u32 v64, v1, 4, 1
    v_bfe_u32 v61, v1, 2, 2
    v_and_b32 v62, 3, v1
    v_lshl_add_u32 v65, v63, 3, v61
    v_lshlrev_b32 v66, 6, v65
    v_lshl_add_u32 v68, v64, 2, v62
    v_add_u32 v68, s73, v68
    v_and_b32 v68, 7, v68
    v_lshl_add_u32 v68, v68, 3, v66
    v_add_u32 v10, 98304, v68
    v_lshl_add_u32 v67, v62, 3, v66
    v_mul_u32_u24 v68, 1056, v64
    v_add_u32 v11, v67, v68
    v_add_u32 v11, 100352, v11
    v_xor_b32 v12, 32, v11
    v_lshlrev_b32 v66, 5, v65
    v_lshl_add_u32 v66, v62, 3, v66
    v_mul_u32_u24 v67, 2176, v64
    v_add_u32 v13, v66, v67
    v_add_u32 v13, 114688, v13
    v_xor_b32 v14, 0x80, v13
    s_mul_i32 s74, s72, 4096
    v_add_u32 v10, s74, v10
    s_mul_i32 s74, s72, 4096
    v_add_u32 v11, s74, v11
    s_mul_i32 s74, s72, 4096
    v_add_u32 v12, s74, v12
    s_mul_i32 s74, s72, 512
    v_add_u32 v13, s74, v13
    s_mul_i32 s74, s72, 512
    v_add_u32 v14, s74, v14
    v_mov_b32 v18, 0
    v_mov_b32 v19, 0
    v_mov_b32 v20, 0
    v_mov_b32 v21, 0
    v_mov_b32 v22, 0
    s_add_u32 m0, s87, 20480
    s_mov_b32 s85, 172928
    buffer_load_dwordx4 v6, s[48:51], s85 offen lds
    s_add_u32 m0, s87, 21504
    s_mov_b32 s85, 173824
    buffer_load_dwordx4 v6, s[48:51], s85 offen lds
    s_add_u32 m0, s87, 22528
    s_mov_b32 s85, 229376
    buffer_load_dwordx4 v7, s[32:35], s85 offen lds
    s_add_u32 m0, s87, 23552
    s_mov_b32 s85, 229376
    buffer_load_dwordx4 v8, s[36:39], s85 offen lds
    s_add_u32 m0, s71, 36864
    s_mov_b32 s85, 229376
    buffer_load_dwordx4 v9, s[52:55], s85 offen lds
    s_add_u32 m0, s70, 4096
    s_add_u32 s85, s69, 128
    buffer_load_dwordx4 v4, s[24:27], s85 offen lds
    s_add_u32 m0, s70, 5120
    s_add_u32 s85, s69, 7296
    buffer_load_dwordx4 v5, s[24:27], s85 offen lds
    s_add_u32 m0, s70, 6144
    s_add_u32 s85, s69, 14464
    buffer_load_dwordx4 v4, s[24:27], s85 offen lds
    s_add_u32 m0, s70, 7168
    s_add_u32 s85, s69, 21632
    buffer_load_dwordx4 v5, s[24:27], s85 offen lds
    s_add_u32 m0, s70, 16384
    s_add_u32 s85, s69, 28800
    buffer_load_dwordx4 v4, s[24:27], s85 offen lds
    v_mov_b32 v140, 0
    v_mov_b32 v141, 0
    v_mov_b32 v142, 0
    v_mov_b32 v143, 0
    v_mov_b32 v144, 0
    v_mov_b32 v145, 0
    v_mov_b32 v146, 0
    v_mov_b32 v147, 0
    v_mov_b32 v148, 0
    v_mov_b32 v149, 0
    v_mov_b32 v150, 0
    v_mov_b32 v151, 0
    v_mov_b32 v152, 0
    v_mov_b32 v153, 0
    v_mov_b32 v154, 0
    v_mov_b32 v155, 0
    v_mov_b32 v156, 0
    v_mov_b32 v157, 0
    v_mov_b32 v158, 0
    v_mov_b32 v159, 0
    v_mov_b32 v134, 0x3f803f80
    v_mov_b32 v135, 0x3f803f80
    s_waitcnt vmcnt(10)
    s_barrier
    s_mov_b32 s40, s22
    s_mov_b32 s41, s23
    s_mov_b32 s42, 20971520
    s_mov_b32 s43, 0x20000
    s_mov_b32 s44, s20
    s_mov_b32 s45, s21
    s_mov_b32 s46, 256
    s_mov_b32 s47, 0x20000
    v_and_b32 v16, 7, v1
    v_lshlrev_b32 v16, 5, v16
    s_cmp_eq_u32 s3, 8
    s_cselect_b32 s74, 0, 0x40000000
    buffer_load_dword v17, v16, s[44:47], s74 offen sc1
    ds_read_b64_tr_b16 v[34:35], v10 offset:0
    ds_read_b64_tr_b16 v[36:37], v10 offset:256
    ds_read_b64_tr_b16 v[38:39], v10 offset:1024
    ds_read_b64_tr_b16 v[40:41], v10 offset:1280
    ds_read_b64_tr_b16 v[42:43], v13 offset:0
    ds_read_b64_tr_b16 v[44:45], v14 offset:0
    ds_read_b64_tr_b16 v[46:47], v11 offset:0
    ds_read_b64_tr_b16 v[48:49], v11 offset:256
    ds_read_b64_tr_b16 v[50:51], v12 offset:0
    ds_read_b64_tr_b16 v[52:53], v12 offset:256
    s_add_u32 m0, s70, 17408
    s_add_u32 s85, s69, 35968
    buffer_load_dwordx4 v5, s[24:27], s85 offen lds
    s_add_u32 m0, s70, 18432
    s_add_u32 s85, s69, 43136
    buffer_load_dwordx4 v4, s[24:27], s85 offen lds
    s_add_u32 m0, s70, 19456
    s_add_u32 s85, s69, 50304
    buffer_load_dwordx4 v5, s[24:27], s85 offen lds
    s_add_u32 m0, s87, 40960
    s_mov_b32 s85, 344960
    buffer_load_dwordx4 v6, s[48:51], s85 offen lds
    s_add_u32 m0, s87, 41984
    s_mov_b32 s85, 345856
    buffer_load_dwordx4 v6, s[48:51], s85 offen lds
    s_add_u32 m0, s87, 43008
    s_mov_b32 s85, 458752
    buffer_load_dwordx4 v7, s[32:35], s85 offen lds
    s_add_u32 m0, s87, 44032
    s_mov_b32 s85, 458752
    buffer_load_dwordx4 v8, s[36:39], s85 offen lds
    s_add_u32 m0, s71, 57344
    s_mov_b32 s85, 458752
    buffer_load_dwordx4 v9, s[52:55], s85 offen lds
    s_add_u32 m0, s70, 8192
    s_add_u32 s85, s69, 256
    buffer_load_dwordx4 v4, s[24:27], s85 offen lds
    s_add_u32 m0, s70, 9216
    s_add_u32 s85, s69, 7424
    buffer_load_dwordx4 v5, s[24:27], s85 offen lds
    s_add_u32 m0, s70, 10240
    s_add_u32 s85, s69, 14592
    buffer_load_dwordx4 v4, s[24:27], s85 offen lds
    s_add_u32 m0, s70, 11264
    s_add_u32 s85, s69, 21760
    buffer_load_dwordx4 v5, s[24:27], s85 offen lds
    s_add_u32 m0, s70, 20480
    s_add_u32 s85, s69, 28928
    buffer_load_dwordx4 v4, s[24:27], s85 offen lds
    s_waitcnt lgkmcnt(0)
    s_waitcnt vmcnt(10)
    s_barrier
    ds_read_b64_tr_b16 v[54:55], v10 offset:20480
    ds_read_b64_tr_b16 v[56:57], v10 offset:20736
    ds_read_b64_tr_b16 v[58:59], v10 offset:21504
    ds_read_b64_tr_b16 v[60:61], v10 offset:21760
    ds_read_b64_tr_b16 v[62:63], v13 offset:20480
    ds_read_b64_tr_b16 v[64:65], v14 offset:20480
    ds_read_b64_tr_b16 v[66:67], v11 offset:20480
    ds_read_b64_tr_b16 v[68:69], v11 offset:20736
    ds_read_b64_tr_b16 v[70:71], v12 offset:20480
    ds_read_b64_tr_b16 v[72:73], v12 offset:20736
    s_add_u32 m0, s70, 21504
    s_add_u32 s85, s69, 36096
    buffer_load_dwordx4 v5, s[24:27], s85 offen lds
    s_add_u32 m0, s70, 22528
    s_add_u32 s85, s69, 43264
    buffer_load_dwordx4 v4, s[24:27], s85 offen lds
    s_add_u32 m0, s70, 23552
    s_add_u32 s85, s69, 50432
    buffer_load_dwordx4 v5, s[24:27], s85 offen lds
    s_add_u32 m0, s87, 0
    s_mov_b32 s85, 516992
    buffer_load_dwordx4 v6, s[48:51], s85 offen lds
    s_add_u32 m0, s87, 1024
    s_mov_b32 s85, 517888
    buffer_load_dwordx4 v6, s[48:51], s85 offen lds
    s_add_u32 m0, s87, 2048
    s_mov_b32 s85, 688128
    buffer_load_dwordx4 v7, s[32:35], s85 offen lds
    s_add_u32 m0, s87, 3072
    s_mov_b32 s85, 688128
    buffer_load_dwordx4 v8, s[36:39], s85 offen lds
    s_add_u32 m0, s71, 16384
    s_mov_b32 s85, 688128
    buffer_load_dwordx4 v9, s[52:55], s85 offen lds
    s_add_u32 m0, s70, 0
    s_add_u32 s85, s69, 384
    buffer_load_dwordx4 v4, s[24:27], s85 offen lds
    s_add_u32 m0, s70, 1024
    s_add_u32 s85, s69, 7552
    buffer_load_dwordx4 v5, s[24:27], s85 offen lds
    s_add_u32 m0, s70, 2048
    s_add_u32 s85, s69, 14720
    buffer_load_dwordx4 v4, s[24:27], s85 offen lds
    s_add_u32 m0, s70, 3072
    s_add_u32 s85, s69, 21888
    buffer_load_dwordx4 v5, s[24:27], s85 offen lds
    s_add_u32 m0, s70, 12288
    s_add_u32 s85, s69, 29056
    buffer_load_dwordx4 v4, s[24:27], s85 offen lds
    s_mov_b32 s60, s8
    s_mov_b32 s61, s9
    s_mov_b32 s62, 25088
    s_mov_b32 s63, 0x20000
    s_mov_b32 s56, s18
    s_mov_b32 s57, s19
    s_mov_b32 s58, 1605632
    s_mov_b32 s59, 0x20000
    s_and_b32 s76, s2, 7
    v_readlane_b32 s98, v17, s76
    s_mov_b32 s77, 0
    s_cmp_eq_u32 s3, 8
    s_cselect_b32 s98, s98, 1
    s_cmp_lg_u32 s98, 0
    s_cbranch_scc1 K_hkv_tok
K_hkv_tokl:
    s_sleep 16
    buffer_load_dword v17, v16, s[44:47], 0 offen sc1
    s_waitcnt vmcnt(0)
    s_waitcnt vmcnt(0)
    v_readlane_b32 s98, v17, s76
    s_add_u32 s77, s77, 1
    s_nop 0
    s_cmp_lg_u32 s98, 0
    s_cbranch_scc1 K_hkv_tok
    s_cmp_lt_u32 s77, 0x4000
    s_cbranch_scc1 K_hkv_tokl
K_hkv_tok:
    v_lshrrev_b32 v164, 2, v16
    v_add_u32 v164, 162112, v164
    ds_read_b64 v[164:165], v164
    v_mov_b32 v166, s98
    v_mov_b32 v167, 0
    s_and_b32 s74, s86, 0xfffffff8
    s_lshl_b32 s74, s74, 4
    s_add_u32 s74, s74, 12582912
    s_cmp_eq_u32 s3, 8
    s_cselect_b32 s74, s74, 0x40000000
    s_mov_b64 exec, 0xff
    s_waitcnt lgkmcnt(0)
    buffer_store_dwordx4 v[164:167], v2, s[40:43], s74 offen sc1
    s_mov_b64 exec, -1
    s_waitcnt vmcnt(11)
    s_barrier
    s_add_u32 m0, s70, 13312
    s_add_u32 s85, s69, 36224
    buffer_load_dwordx4 v5, s[24:27], s85 offen lds
    s_add_u32 m0, s70, 14336
    s_add_u32 s85, s69, 43392
    buffer_load_dwordx4 v4, s[24:27], s85 offen lds
    s_add_u32 m0, s70, 15360
    s_add_u32 s85, s69, 50560
    buffer_load_dwordx4 v5, s[24:27], s85 offen lds
    s_add_u32 m0, s87, 20480
    s_mov_b32 s85, 689024
    buffer_load_dwordx4 v6, s[48:51], s85 offen lds
    s_add_u32 m0, s87, 21504
    s_mov_b32 s85, 689920
    buffer_load_dwordx4 v6, s[48:51], s85 offen lds
    s_add_u32 m0, s87, 22528
    s_mov_b32 s85, 917504
    buffer_load_dwordx4 v7, s[32:35], s85 offen lds
    s_add_u32 m0, s87, 23552
    s_mov_b32 s85, 917504
    buffer_load_dwordx4 v8, s[36:39], s85 offen lds
    s_add_u32 m0, s71, 36864
    s_mov_b32 s85, 917504
    buffer_load_dwordx4 v9, s[52:55], s85 offen lds
    s_add_u32 m0, s70, 4096
    s_add_u32 s85, s69, 512
    buffer_load_dwordx4 v4, s[24:27], s85 offen lds
    s_add_u32 m0, s70, 5120
    s_add_u32 s85, s69, 7680
    buffer_load_dwordx4 v5, s[24:27], s85 offen lds
    s_add_u32 m0, s70, 6144
    s_add_u32 s85, s69, 14848
    buffer_load_dwordx4 v4, s[24:27], s85 offen lds
    s_add_u32 m0, s70, 7168
    s_add_u32 s85, s69, 22016
    buffer_load_dwordx4 v5, s[24:27], s85 offen lds
    s_add_u32 m0, s70, 16384
    s_add_u32 s85, s69, 29184
    buffer_load_dwordx4 v4, s[24:27], s85 offen lds
    s_add_u32 m0, s70, 17408
    s_add_u32 s85, s69, 36352
    buffer_load_dwordx4 v5, s[24:27], s85 offen lds
    ds_read_b64_tr_b16 v[74:75], v10 offset:40960
    ds_read_b64_tr_b16 v[76:77], v10 offset:41216
    ds_read_b64_tr_b16 v[78:79], v10 offset:41984
    ds_read_b64_tr_b16 v[80:81], v10 offset:42240
    ds_read_b64_tr_b16 v[82:83], v13 offset:40960
    ds_read_b64_tr_b16 v[84:85], v14 offset:40960
    ds_read_b64_tr_b16 v[86:87], v11 offset:40960
    ds_read_b64_tr_b16 v[88:89], v11 offset:41216
    ds_read_b64_tr_b16 v[90:91], v12 offset:40960
    ds_read_b64_tr_b16 v[92:93], v12 offset:41216
    v_mfma_f32_4x4x4_16b_bf16 v[140:143], v[134:135], v[34:35], v[140:143]
    v_mfma_f32_4x4x4_16b_bf16 v[144:147], v[134:135], v[38:39], v[144:147]
    v_mfma_f32_4x4x4_16b_bf16 v[148:151], v[134:135], v[42:43], v[148:151]
    v_mfma_f32_4x4x4_16b_bf16 v[152:155], v[134:135], v[46:47], v[152:155]
    v_mfma_f32_4x4x4_16b_bf16 v[156:159], v[134:135], v[50:51], v[156:159]
    v_mfma_f32_4x4x4_16b_bf16 v[140:143], v[134:135], v[36:37], v[140:143]
    v_mfma_f32_4x4x4_16b_bf16 v[144:147], v[134:135], v[40:41], v[144:147]
    v_mfma_f32_4x4x4_16b_bf16 v[148:151], v[134:135], v[44:45], v[148:151]
    v_mfma_f32_4x4x4_16b_bf16 v[152:155], v[134:135], v[48:49], v[152:155]
    v_mfma_f32_4x4x4_16b_bf16 v[156:159], v[134:135], v[52:53], v[156:159]
    s_waitcnt lgkmcnt(0)
    s_waitcnt vmcnt(11)
    s_barrier
    s_add_u32 m0, s70, 18432
    s_add_u32 s85, s69, 43520
    buffer_load_dwordx4 v4, s[24:27], s85 offen lds
    s_add_u32 m0, s70, 19456
    s_add_u32 s85, s69, 50688
    buffer_load_dwordx4 v5, s[24:27], s85 offen lds
    s_add_u32 m0, s87, 40960
    s_mov_b32 s85, 861056
    buffer_load_dwordx4 v6, s[48:51], s85 offen lds
    s_add_u32 m0, s87, 41984
    s_mov_b32 s85, 861952
    buffer_load_dwordx4 v6, s[48:51], s85 offen lds
    s_add_u32 m0, s87, 43008
    s_mov_b32 s85, 1146880
    buffer_load_dwordx4 v7, s[32:35], s85 offen lds
    s_add_u32 m0, s87, 44032
    s_mov_b32 s85, 1146880
    buffer_load_dwordx4 v8, s[36:39], s85 offen lds
    s_add_u32 m0, s71, 57344
    s_mov_b32 s85, 1146880
    buffer_load_dwordx4 v9, s[52:55], s85 offen lds
    s_add_u32 m0, s70, 8192
    s_add_u32 s85, s69, 640
    buffer_load_dwordx4 v4, s[24:27], s85 offen lds
    s_add_u32 m0, s70, 9216
    s_add_u32 s85, s69, 7808
    buffer_load_dwordx4 v5, s[24:27], s85 offen lds
    s_add_u32 m0, s70, 10240
    s_add_u32 s85, s69, 14976
    buffer_load_dwordx4 v4, s[24:27], s85 offen lds
    s_add_u32 m0, s70, 11264
    s_add_u32 s85, s69, 22144
    buffer_load_dwordx4 v5, s[24:27], s85 offen lds
    s_add_u32 m0, s70, 20480
    s_add_u32 s85, s69, 29312
    buffer_load_dwordx4 v4, s[24:27], s85 offen lds
    s_add_u32 m0, s70, 21504
    s_add_u32 s85, s69, 36480
    buffer_load_dwordx4 v5, s[24:27], s85 offen lds
    s_add_u32 m0, s70, 22528
    s_add_u32 s85, s69, 43648
    buffer_load_dwordx4 v4, s[24:27], s85 offen lds
    ds_read_b64_tr_b16 v[94:95], v10 offset:0
    ds_read_b64_tr_b16 v[96:97], v10 offset:256
    ds_read_b64_tr_b16 v[98:99], v10 offset:1024
    ds_read_b64_tr_b16 v[100:101], v10 offset:1280
    ds_read_b64_tr_b16 v[102:103], v13 offset:0
    ds_read_b64_tr_b16 v[104:105], v14 offset:0
    ds_read_b64_tr_b16 v[106:107], v11 offset:0
    ds_read_b64_tr_b16 v[108:109], v11 offset:256
    ds_read_b64_tr_b16 v[110:111], v12 offset:0
    ds_read_b64_tr_b16 v[112:113], v12 offset:256
    v_mfma_f32_4x4x4_16b_bf16 v[140:143], v[134:135], v[54:55], v[140:143]
    v_mfma_f32_4x4x4_16b_bf16 v[144:147], v[134:135], v[58:59], v[144:147]
    v_mfma_f32_4x4x4_16b_bf16 v[148:151], v[134:135], v[62:63], v[148:151]
    v_mfma_f32_4x4x4_16b_bf16 v[152:155], v[134:135], v[66:67], v[152:155]
    v_mfma_f32_4x4x4_16b_bf16 v[156:159], v[134:135], v[70:71], v[156:159]
    v_mfma_f32_4x4x4_16b_bf16 v[140:143], v[134:135], v[56:57], v[140:143]
    v_mfma_f32_4x4x4_16b_bf16 v[144:147], v[134:135], v[60:61], v[144:147]
    v_mfma_f32_4x4x4_16b_bf16 v[148:151], v[134:135], v[64:65], v[148:151]
    v_mfma_f32_4x4x4_16b_bf16 v[152:155], v[134:135], v[68:69], v[152:155]
    v_mfma_f32_4x4x4_16b_bf16 v[156:159], v[134:135], v[72:73], v[156:159]
    s_waitcnt lgkmcnt(0)
    s_waitcnt vmcnt(12)
    s_barrier
    s_add_u32 m0, s70, 23552
    s_add_u32 s85, s69, 50816
    buffer_load_dwordx4 v5, s[24:27], s85 offen lds
    s_add_u32 m0, s87, 0
    s_mov_b32 s85, 1033088
    buffer_load_dwordx4 v6, s[48:51], s85 offen lds
    s_add_u32 m0, s87, 1024
    s_mov_b32 s85, 1033984
    buffer_load_dwordx4 v6, s[48:51], s85 offen lds
    s_add_u32 m0, s87, 2048
    s_mov_b32 s85, 1376256
    buffer_load_dwordx4 v7, s[32:35], s85 offen lds
    s_add_u32 m0, s87, 3072
    s_mov_b32 s85, 1376256
    buffer_load_dwordx4 v8, s[36:39], s85 offen lds
    s_add_u32 m0, s71, 16384
    s_mov_b32 s85, 1376256
    buffer_load_dwordx4 v9, s[52:55], s85 offen lds
    s_add_u32 m0, s70, 0
    s_add_u32 s85, s69, 768
    buffer_load_dwordx4 v4, s[24:27], s85 offen lds
    s_add_u32 m0, s70, 1024
    s_add_u32 s85, s69, 7936
    buffer_load_dwordx4 v5, s[24:27], s85 offen lds
    s_add_u32 m0, s70, 2048
    s_add_u32 s85, s69, 15104
    buffer_load_dwordx4 v4, s[24:27], s85 offen lds
    s_add_u32 m0, s70, 3072
    s_add_u32 s85, s69, 22272
    buffer_load_dwordx4 v5, s[24:27], s85 offen lds
    s_add_u32 m0, s70, 12288
    s_add_u32 s85, s69, 29440
    buffer_load_dwordx4 v4, s[24:27], s85 offen lds
    s_add_u32 m0, s70, 13312
    s_add_u32 s85, s69, 36608
    buffer_load_dwordx4 v5, s[24:27], s85 offen lds
    s_add_u32 m0, s70, 14336
    s_add_u32 s85, s69, 43776
    buffer_load_dwordx4 v4, s[24:27], s85 offen lds
    s_add_u32 m0, s70, 15360
    s_add_u32 s85, s69, 50944
    buffer_load_dwordx4 v5, s[24:27], s85 offen lds
    v_mov_b32 v160, -1
    v_mov_b32 v161, -1
    v_mov_b32 v162, -1
    v_mov_b32 v163, -1
    s_lshl_b32 s74, s67, 3
    s_add_u32 s74, s74, s64
    s_lshl_b32 s74, s74, 2
    s_add_u32 s74, s74, s72
    s_lshl_b32 s74, s74, 11
    s_add_u32 s74, s74, 11534336
    buffer_store_dwordx4 v[160:163], v2, s[40:43], s74 offen offset:0 sc1
    buffer_store_dwordx4 v[160:163], v2, s[40:43], s74 offen offset:1024 sc1
    ds_read_b64_tr_b16 v[114:115], v10 offset:20480
    ds_read_b64_tr_b16 v[116:117], v10 offset:20736
    ds_read_b64_tr_b16 v[118:119], v10 offset:21504
    ds_read_b64_tr_b16 v[120:121], v10 offset:21760
    ds_read_b64_tr_b16 v[122:123], v13 offset:20480
    ds_read_b64_tr_b16 v[124:125], v14 offset:20480
    ds_read_b64_tr_b16 v[126:127], v11 offset:20480
    ds_read_b64_tr_b16 v[128:129], v11 offset:20736
    ds_read_b64_tr_b16 v[130:131], v12 offset:20480
    ds_read_b64_tr_b16 v[132:133], v12 offset:20736
    v_mfma_f32_4x4x4_16b_bf16 v[140:143], v[134:135], v[74:75], v[140:143]
    v_mfma_f32_4x4x4_16b_bf16 v[144:147], v[134:135], v[78:79], v[144:147]
    v_mfma_f32_4x4x4_16b_bf16 v[148:151], v[134:135], v[82:83], v[148:151]
    v_mfma_f32_4x4x4_16b_bf16 v[152:155], v[134:135], v[86:87], v[152:155]
    v_mfma_f32_4x4x4_16b_bf16 v[156:159], v[134:135], v[90:91], v[156:159]
    v_mfma_f32_4x4x4_16b_bf16 v[140:143], v[134:135], v[76:77], v[140:143]
    v_mfma_f32_4x4x4_16b_bf16 v[144:147], v[134:135], v[80:81], v[144:147]
    v_mfma_f32_4x4x4_16b_bf16 v[148:151], v[134:135], v[84:85], v[148:151]
    v_mfma_f32_4x4x4_16b_bf16 v[152:155], v[134:135], v[88:89], v[152:155]
    v_mfma_f32_4x4x4_16b_bf16 v[156:159], v[134:135], v[92:93], v[156:159]
    s_waitcnt lgkmcnt(0)
    s_waitcnt vmcnt(15)
    s_barrier
    s_waitcnt vmcnt(0)
    s_lshl_b32 s99, s64, 2
    s_add_u32 s99, s99, s72
    s_lshl_b32 s99, s99, 10
    s_add_u32 s99, s99, 12582912
    buffer_load_dwordx3 v[160:162], v2, s[40:43], s99 offen sc1
    v_lshrrev_b32 v164, 4, v1
    s_lshl_b32 s74, s72, 3
    s_add_u32 s74, s74, 0
    v_add_u32 v164, s74, v164
    v_bfe_u32 v165, v1, 3, 1
    v_and_b32 v166, 7, v1
    v_mad_u32_u24 v165, v165, 7, v166
    v_mad_u32_u24 v165, v164, 14, v165
    v_lshlrev_b32 v165, 2, v165
    v_cmp_eq_u32_e64 s[88:89], 7, v166
    s_cmp_eq_u32 s74, 28
    s_cselect_b64 s[88:89], -1, s[88:89]
    v_mov_b32 v166, 0x7fffff00
    v_cndmask_b32_e64 v165, v165, v166, s[88:89]
    s_mul_i32 s75, s67, 1568
    s_lshl_b32 s74, s74, 6
    s_add_u32 m0, s74, 159744
    s_nop 0
    buffer_load_dword v165, s[60:63], s75 offen lds
    v_lshrrev_b32 v164, 4, v1
    s_lshl_b32 s74, s72, 3
    s_add_u32 s74, s74, 4
    v_add_u32 v164, s74, v164
    v_bfe_u32 v165, v1, 3, 1
    v_and_b32 v166, 7, v1
    v_mad_u32_u24 v165, v165, 7, v166
    v_mad_u32_u24 v165, v164, 14, v165
    v_lshlrev_b32 v165, 2, v165
    v_cmp_eq_u32_e64 s[88:89], 7, v166
    s_cmp_eq_u32 s74, 28
    s_cselect_b64 s[88:89], -1, s[88:89]
    v_mov_b32 v166, 0x7fffff00
    v_cndmask_b32_e64 v165, v165, v166, s[88:89]
    s_mul_i32 s75, s67, 1568
    s_lshl_b32 s74, s74, 6
    s_add_u32 m0, s74, 159744
    s_nop 0
    buffer_load_dword v165, s[60:63], s75 offen lds
    ds_read_b64_tr_b16 v[34:35], v10 offset:40960
    ds_read_b64_tr_b16 v[36:37], v10 offset:41216
    ds_read_b64_tr_b16 v[38:39], v10 offset:41984
    ds_read_b64_tr_b16 v[40:41], v10 offset:42240
    ds_read_b64_tr_b16 v[42:43], v13 offset:40960
    ds_read_b64_tr_b16 v[44:45], v14 offset:40960
    ds_read_b64_tr_b16 v[46:47], v11 offset:40960
    ds_read_b64_tr_b16 v[48:49], v11 offset:41216
    ds_read_b64_tr_b16 v[50:51], v12 offset:40960
    ds_read_b64_tr_b16 v[52:53], v12 offset:41216
    v_mfma_f32_4x4x4_16b_bf16 v[140:143], v[134:135], v[94:95], v[140:143]
    v_mfma_f32_4x4x4_16b_bf16 v[144:147], v[134:135], v[98:99], v[144:147]
    v_mfma_f32_4x4x4_16b_bf16 v[148:151], v[134:135], v[102:103], v[148:151]
    v_mfma_f32_4x4x4_16b_bf16 v[152:155], v[134:135], v[106:107], v[152:155]
    v_mfma_f32_4x4x4_16b_bf16 v[156:159], v[134:135], v[110:111], v[156:159]
    v_mfma_f32_4x4x4_16b_bf16 v[140:143], v[134:135], v[96:97], v[140:143]
    v_mfma_f32_4x4x4_16b_bf16 v[144:147], v[134:135], v[100:101], v[144:147]
    v_mfma_f32_4x4x4_16b_bf16 v[148:151], v[134:135], v[104:105], v[148:151]
    v_mfma_f32_4x4x4_16b_bf16 v[152:155], v[134:135], v[108:109], v[152:155]
    v_mfma_f32_4x4x4_16b_bf16 v[156:159], v[134:135], v[112:113], v[156:159]
    v_mfma_f32_4x4x4_16b_bf16 v[140:143], v[134:135], v[114:115], v[140:143]
    v_mfma_f32_4x4x4_16b_bf16 v[144:147], v[134:135], v[118:119], v[144:147]
    v_mfma_f32_4x4x4_16b_bf16 v[148:151], v[134:135], v[122:123], v[148:151]
    v_mfma_f32_4x4x4_16b_bf16 v[152:155], v[134:135], v[126:127], v[152:155]
    v_mfma_f32_4x4x4_16b_bf16 v[156:159], v[134:135], v[130:131], v[156:159]
    v_mfma_f32_4x4x4_16b_bf16 v[140:143], v[134:135], v[116:117], v[140:143]
    v_mfma_f32_4x4x4_16b_bf16 v[144:147], v[134:135], v[120:121], v[144:147]
    v_mfma_f32_4x4x4_16b_bf16 v[148:151], v[134:135], v[124:125], v[148:151]
    v_mfma_f32_4x4x4_16b_bf16 v[152:155], v[134:135], v[128:129], v[152:155]
    v_mfma_f32_4x4x4_16b_bf16 v[156:159], v[134:135], v[132:133], v[156:159]
    s_cmp_lg_u32 s3, 8
    s_cbranch_scc1 K_hkv_tk2_ok
    v_and_b32 v16, 7, v1
    v_lshlrev_b32 v16, 5, v16
    s_mov_b32 s77, 0
K_hkv_tk2_loop:
    buffer_load_dword v17, v16, s[44:47], 0 offen sc1
K_hkv_tk2_chk:
    s_waitcnt vmcnt(0)
    s_add_u32 s77, s77, 1
    s_waitcnt vmcnt(0)
    v_cmp_eq_u32_e64 s[88:89], 0, v17
    s_nop 0
    s_cmp_eq_u64 s[88:89], 0
    s_cbranch_scc1 K_hkv_tk2_wr
    s_sleep 16
    s_cmp_lt_u32 s77, 0x4000
    s_cbranch_scc1 K_hkv_tk2_loop
K_hkv_tk2_wr:
    v_lshrrev_b32 v16, 3, v16
    v_add_u32 v16, 162048, v16
    s_waitcnt vmcnt(0)
    ds_write_b32 v16, v17
K_hkv_tk2_ok:
    s_waitcnt lgkmcnt(0)
    s_barrier
    s_cmp_lg_u32 s3, 8
    s_cbranch_scc1 K_hkv_nosigkp
    s_lshr_b32 s75, s67, 2
    s_lshl_b32 s75, s75, 1
    s_and_b32 s76, s67, 3
    s_lshl_b32 s76, s76, 6
    s_add_u32 s75, s75, s76
    s_mul_i32 s75, s75, 4352
    s_lshl_b32 s76, s64, 2
    s_add_u32 s75, s75, s76
    s_add_u32 s75, s75, 14680192
    v_and_b32 v166, 3, v1
    v_lshlrev_b32 v166, 3, v166
    v_lshrrev_b32 v164, 2, v1
    v_add_u32 v166, v166, v164
    v_mul_u32_u24 v166, 4352, v166
    v_mov_b32 v165, s98
    s_mov_b64 exec, 0xff
    buffer_store_dword v165, v166, s[40:43], s75 offen sc1
    s_mov_b64 exec, -1
K_hkv_nosigkp:
    s_lshl_b32 s74, s72, 1
    s_lshr_b32 s75, s64, 2
    s_add_u32 s74, s74, s75
    s_lshl_b32 s74, s74, 2
    s_add_u32 s74, s74, 162048
    v_mov_b32 v163, s74
    ds_read_b32 v163, v163
    s_waitcnt lgkmcnt(0)
    v_readfirstlane_b32 s78, v163
    s_waitcnt vmcnt(2)
    s_nop 0
    v_cmp_ne_u32_e64 s[88:89], s78, v162
    s_mov_b32 s77, 0
    s_cmp_eq_u64 s[88:89], 0
    s_cbranch_scc1 K_hkv_stok
K_hkv_st:
    s_sleep 8
    buffer_load_dwordx3 v[160:162], v2, s[40:43], s99 offen sc1
    s_waitcnt vmcnt(0)
    s_waitcnt vmcnt(0)
    v_cmp_ne_u32_e64 s[88:89], s78, v162
    s_add_u32 s77, s77, 1
    s_nop 0
    s_cmp_eq_u64 s[88:89], 0
    s_cbranch_scc1 K_hkv_stok
    s_cmp_lt_u32 s77, 0x8000
    s_cbranch_scc1 K_hkv_st
K_hkv_stok:
    v_lshlrev_b32 v163, 3, v1
    s_lshl_b32 s74, s72, 9
    s_add_u32 s74, s74, 156672
    v_add_u32 v163, s74, v163
    ds_write_b64 v163, v[160:161]
    s_lshr_b32 s74, s2, 3
    s_lshl_b32 s74, s74, 2
    s_add_u32 s74, s74, s72
    s_lshl_b32 s74, s74, 14
    s_mov_b32 s77, 1605632
    s_cmp_lt_u32 s74, s77
    s_cselect_b32 s12, s18, s10
    s_cselect_b32 s13, s19, s11
    s_cselect_b32 s14, s77, 401408
    s_mov_b32 s15, 0x20000
    s_cselect_b32 s77, 0, s77
    s_sub_u32 s74, s74, s77
    v_lshlrev_b32 v16, 7, v1
    s_add_u32 s75, s74, 0x2000
    buffer_load_dword v163, v16, s[12:15], s74 offen
    buffer_load_dword v164, v16, s[12:15], s75 offen
    ds_read_b64_tr_b16 v[54:55], v10 offset:0
    ds_read_b64_tr_b16 v[56:57], v10 offset:256
    ds_read_b64_tr_b16 v[58:59], v10 offset:1024
    ds_read_b64_tr_b16 v[60:61], v10 offset:1280
    ds_read_b64_tr_b16 v[62:63], v13 offset:0
    ds_read_b64_tr_b16 v[64:65], v14 offset:0
    ds_read_b64_tr_b16 v[66:67], v11 offset:0
    ds_read_b64_tr_b16 v[68:69], v11 offset:256
    ds_read_b64_tr_b16 v[70:71], v12 offset:0
    ds_read_b64_tr_b16 v[72:73], v12 offset:256
    v_mfma_f32_4x4x4_16b_bf16 v[140:143], v[134:135], v[34:35], v[140:143]
    v_mfma_f32_4x4x4_16b_bf16 v[144:147], v[134:135], v[38:39], v[144:147]
    v_mfma_f32_4x4x4_16b_bf16 v[148:151], v[134:135], v[42:43], v[148:151]
    v_mfma_f32_4x4x4_16b_bf16 v[152:155], v[134:135], v[46:47], v[152:155]
    v_mfma_f32_4x4x4_16b_bf16 v[156:159], v[134:135], v[50:51], v[156:159]
    v_mfma_f32_4x4x4_16b_bf16 v[140:143], v[134:135], v[36:37], v[140:143]
    v_mfma_f32_4x4x4_16b_bf16 v[144:147], v[134:135], v[40:41], v[144:147]
    v_mfma_f32_4x4x4_16b_bf16 v[148:151], v[134:135], v[44:45], v[148:151]
    v_mfma_f32_4x4x4_16b_bf16 v[152:155], v[134:135], v[48:49], v[152:155]
    v_mfma_f32_4x4x4_16b_bf16 v[156:159], v[134:135], v[52:53], v[156:159]
    s_waitcnt lgkmcnt(9)
    v_mfma_f32_4x4x4_16b_bf16 v[140:143], v[134:135], v[54:55], v[140:143]
    s_waitcnt lgkmcnt(7)
    v_mfma_f32_4x4x4_16b_bf16 v[144:147], v[134:135], v[58:59], v[144:147]
    s_waitcnt lgkmcnt(5)
    v_mfma_f32_4x4x4_16b_bf16 v[148:151], v[134:135], v[62:63], v[148:151]
    s_waitcnt lgkmcnt(3)
    v_mfma_f32_4x4x4_16b_bf16 v[152:155], v[134:135], v[66:67], v[152:155]
    s_waitcnt lgkmcnt(1)
    v_mfma_f32_4x4x4_16b_bf16 v[156:159], v[134:135], v[70:71], v[156:159]
    v_mfma_f32_4x4x4_16b_bf16 v[140:143], v[134:135], v[56:57], v[140:143]
    v_mfma_f32_4x4x4_16b_bf16 v[144:147], v[134:135], v[60:61], v[144:147]
    v_mfma_f32_4x4x4_16b_bf16 v[148:151], v[134:135], v[64:65], v[148:151]
    v_mfma_f32_4x4x4_16b_bf16 v[152:155], v[134:135], v[68:69], v[152:155]
    s_waitcnt lgkmcnt(0)
    v_mfma_f32_4x4x4_16b_bf16 v[156:159], v[134:135], v[72:73], v[156:159]
    s_nop 2
    v_mov_b32 v18, v140
    v_mov_b32 v19, v144
    v_mov_b32 v20, v148
    v_mov_b32 v21, v152
    s_nop 0
    v_mov_b32 v22, v156
    s_lshl_b32 s74, s72, 2
    s_add_u32 s74, s74, 147456
    v_add_u32 v136, s74, v2
    v_cvt_pk_bf16_f32 v137, v18, v18
    v_cvt_pk_bf16_f32 v138, v19, v19
    v_cvt_pk_bf16_f32 v139, v20, v20
    v_cvt_pk_bf16_f32 v140, v21, v21
    v_cvt_pk_bf16_f32 v141, v22, v22
    v_lshlrev_b32 v137, 16, v137
    v_lshlrev_b32 v138, 16, v138
    v_lshlrev_b32 v139, 16, v139
    v_lshlrev_b32 v140, 16, v140
    v_lshlrev_b32 v141, 16, v141
    v_sub_f32 v137, v18, v137
    v_sub_f32 v138, v19, v138
    v_sub_f32 v139, v20, v139
    v_sub_f32 v140, v21, v140
    v_sub_f32 v141, v22, v141
    v_cvt_pk_bf16_f32 v137, v18, v137
    v_cvt_pk_bf16_f32 v138, v19, v138
    v_cvt_pk_bf16_f32 v139, v20, v139
    v_cvt_pk_bf16_f32 v140, v21, v140
    v_cvt_pk_bf16_f32 v141, v22, v141
    ds_write_b32 v136, v137 offset:0
    ds_write_b32 v136, v138 offset:1024
    ds_write_b32 v136, v139 offset:2048
    ds_write_b32 v136, v140 offset:3072
    ds_write_b32 v136, v141 offset:4096
    s_waitcnt vmcnt(2)
    s_waitcnt lgkmcnt(0)
K_hpost_kv:
    s_and_b32 s74, s2, 7
    s_lshr_b32 s75, s2, 3
    s_and_b32 s76, s74, 1
    s_lshl_b32 s76, s76, 2
    s_lshr_b32 s74, s74, 1
    s_add_u32 s73, s74, s76
    s_lshl_b32 s65, s73, 2
    s_and_b32 s76, s75, 3
    s_add_u32 s65, s65, s76
    s_lshr_b32 s66, s75, 2
    v_lshrrev_b32 v60, 3, v1
    v_and_b32 v61, 7, v1
    v_bfe_u32 v62, v1, 4, 1
    v_lshlrev_b32 v62, 2, v62
    v_xor_b32 v61, v61, v62
    s_lshl_b32 s74, s66, 7
    v_lshlrev_b32 v61, 4, v61
    v_add_u32 v61, s74, v61
    v_mul_u32_u24 v18, 896, v60
    v_add_u32 v18, v18, v61
    s_mul_i32 s70, s72, 36864
    s_and_b32 s74, s72, 1
    s_lshl_b32 s74, s74, 2
    s_lshr_b32 s75, s72, 1
    s_add_u32 s74, s74, s75
    s_mul_i32 s69, s74, 200704
    s_cmp_ge_u32 s2, 224
    s_cselect_b32 s74, 0x40000000, 0
    s_add_u32 s69, s69, s74
    v_lshrrev_b32 v20, 4, v1
    v_bfe_u32 v21, v1, 2, 2
    v_lshl_add_u32 v20, v20, 3, v21
    v_bfe_u32 v22, v1, 1, 1
    s_lshl_b32 s74, s72, 1
    v_add_u32 v24, s74, v22
    v_xor_b32 v24, v24, v21
    v_lshlrev_b32 v23, 7, v20
    v_lshl_add_u32 v23, v24, 4, v23
    v_and_b32 v25, 1, v1
    v_lshl_add_u32 v4, v25, 3, v23
    v_add_u32 v4, 12288, v4
    v_xor_b32 v5, 64, v4
    v_lshrrev_b32 v24, 1, v21
    v_xor_b32 v24, v24, v22
    v_lshlrev_b32 v23, 6, v20
    v_lshl_add_u32 v23, v24, 4, v23
    v_lshl_add_u32 v10, v25, 3, v23
    v_add_u32 v10, 16384, v10
    v_xor_b32 v11, 32, v10
    v_add_u32 v6, 55296, v4
    v_add_u32 v12, 55296, v10
    v_add_u32 v7, 55296, v5
    v_add_u32 v13, 55296, v11
    v_add_u32 v8, 110592, v4
    v_add_u32 v14, 110592, v10
    v_add_u32 v9, 110592, v5
    v_add_u32 v15, 110592, v11
    s_lshl_b32 s78, s67, 3
    s_add_u32 s78, s78, s64
    s_lshl_b32 s78, s78, 13
    s_lshr_b32 s74, s72, 1
    s_lshl_b32 s74, s74, 12
    s_add_u32 s78, s78, s74
    s_and_b32 s74, s72, 1
    s_lshl_b32 s74, s74, 9
    s_add_u32 s78, s78, s74
    s_add_u32 s78, s78, 11534336
    v_bfe_u32 v20, v1, 2, 2
    v_and_b32 v21, 3, v1
    v_lshl_add_u32 v20, v20, 3, v21
    v_add_u32 v20, 0, v20
    v_cmp_lt_u32_e64 s[88:89], 13, v20
    v_subrev_u32 v21, 14, v20
    s_nop 0
    v_cndmask_b32_e64 v21, v20, v21, s[88:89]
    v_cndmask_b32_e64 v22, 0, 4, s[88:89]
    v_cmp_lt_u32_e64 s[90:91], 27, v20
    v_and_b32 v23, 1, v20
    v_lshlrev_b32 v23, 2, v23
    v_bfe_u32 v24, v20, 1, 1
    v_add_u32 v24, 14, v24
    v_cndmask_b32_e64 v21, v21, v24, s[90:91]
    v_cndmask_b32_e64 v22, v22, v23, s[90:91]
    v_lshrrev_b32 v23, 2, v21
    v_and_b32 v21, 3, v21
    v_lshl_add_u32 v21, v23, 3, v21
    v_add_u32 v21, v21, v22
    v_lshrrev_b32 v22, 4, v1
    v_lshlrev_b32 v22, 10, v22
    v_lshl_add_u32 v130, v21, 4, v22
    v_bfe_u32 v20, v1, 2, 2
    v_and_b32 v21, 3, v1
    v_lshl_add_u32 v20, v20, 3, v21
    v_add_u32 v20, 4, v20
    v_cmp_lt_u32_e64 s[88:89], 13, v20
    v_subrev_u32 v21, 14, v20
    s_nop 0
    v_cndmask_b32_e64 v21, v20, v21, s[88:89]
    v_cndmask_b32_e64 v22, 0, 4, s[88:89]
    v_cmp_lt_u32_e64 s[90:91], 27, v20
    v_and_b32 v23, 1, v20
    v_lshlrev_b32 v23, 2, v23
    v_bfe_u32 v24, v20, 1, 1
    v_add_u32 v24, 14, v24
    v_cndmask_b32_e64 v21, v21, v24, s[90:91]
    v_cndmask_b32_e64 v22, v22, v23, s[90:91]
    v_lshrrev_b32 v23, 2, v21
    v_and_b32 v21, 3, v21
    v_lshl_add_u32 v21, v23, 3, v21
    v_add_u32 v21, v21, v22
    v_lshrrev_b32 v22, 4, v1
    v_lshlrev_b32 v22, 10, v22
    v_lshl_add_u32 v131, v21, 4, v22
    s_barrier
    s_setprio 0
    s_add_u32 m0, s70, 0
    s_add_u32 s85, s69, 0
    buffer_load_dwordx4 v18, s[56:59], s85 offen lds
    s_add_u32 m0, s70, 1024
    s_add_u32 s85, s69, 7168
    buffer_load_dwordx4 v18, s[56:59], s85 offen lds
    s_add_u32 m0, s70, 18432
    s_add_u32 s85, s69, 401408
    buffer_load_dwordx4 v18, s[56:59], s85 offen lds
    s_add_u32 m0, s70, 19456
    s_add_u32 s85, s69, 408576
    buffer_load_dwordx4 v18, s[56:59], s85 offen lds
    s_add_u32 m0, s70, 2048
    s_add_u32 s85, s69, 14336
    buffer_load_dwordx4 v18, s[56:59], s85 offen lds
    s_add_u32 m0, s70, 3072
    s_add_u32 s85, s69, 21504
    buffer_load_dwordx4 v18, s[56:59], s85 offen lds
    s_add_u32 m0, s70, 20480
    s_add_u32 s85, s69, 415744
    buffer_load_dwordx4 v18, s[56:59], s85 offen lds
    s_add_u32 m0, s70, 21504
    s_add_u32 s85, s69, 422912
    buffer_load_dwordx4 v18, s[56:59], s85 offen lds
    s_add_u32 m0, s70, 4096
    s_add_u32 s85, s69, 28672
    buffer_load_dwordx4 v18, s[56:59], s85 offen lds
    s_add_u32 m0, s70, 5120
    s_add_u32 s85, s69, 35840
    buffer_load_dwordx4 v18, s[56:59], s85 offen lds
    s_add_u32 m0, s70, 22528
    s_add_u32 s85, s69, 430080
    buffer_load_dwordx4 v18, s[56:59], s85 offen lds
    s_add_u32 m0, s70, 23552
    s_add_u32 s85, s69, 437248
    buffer_load_dwordx4 v18, s[56:59], s85 offen lds
    s_add_u32 m0, s70, 6144
    s_add_u32 s85, s69, 43008
    buffer_load_dwordx4 v18, s[56:59], s85 offen lds
    s_add_u32 m0, s70, 7168
    s_add_u32 s85, s69, 50176
    buffer_load_dwordx4 v18, s[56:59], s85 offen lds
    s_add_u32 m0, s70, 24576
    s_add_u32 s85, s69, 444416
    buffer_load_dwordx4 v18, s[56:59], s85 offen lds
    s_add_u32 m0, s70, 25600
    s_add_u32 s85, s69, 451584
    buffer_load_dwordx4 v18, s[56:59], s85 offen lds
    s_add_u32 m0, s70, 8192
    s_add_u32 s85, s69, 57344
    buffer_load_dwordx4 v18, s[56:59], s85 offen lds
    s_add_u32 m0, s70, 9216
    s_add_u32 s85, s69, 64512
    buffer_load_dwordx4 v18, s[56:59], s85 offen lds
    s_add_u32 m0, s70, 26624
    s_add_u32 s85, s69, 458752
    buffer_load_dwordx4 v18, s[56:59], s85 offen lds
    s_add_u32 m0, s70, 27648
    s_add_u32 s85, s69, 465920
    buffer_load_dwordx4 v18, s[56:59], s85 offen lds
    s_add_u32 m0, s70, 10240
    s_add_u32 s85, s69, 71680
    buffer_load_dwordx4 v18, s[56:59], s85 offen lds
    s_add_u32 m0, s70, 11264
    s_add_u32 s85, s69, 78848
    buffer_load_dwordx4 v18, s[56:59], s85 offen lds
    s_add_u32 m0, s70, 28672
    s_add_u32 s85, s69, 473088
    buffer_load_dwordx4 v18, s[56:59], s85 offen lds
    s_add_u32 m0, s70, 29696
    s_add_u32 s85, s69, 480256
    buffer_load_dwordx4 v18, s[56:59], s85 offen lds
    s_barrier
    s_setprio 3
    ds_read_b64_tr_b16 v[32:33], v4 offset:0
    ds_read_b64_tr_b16 v[36:37], v10 offset:0
    ds_read_b64_tr_b16 v[40:41], v11 offset:0
    ds_read_b64_tr_b16 v[34:35], v5 offset:512
    ds_read_b64_tr_b16 v[38:39], v11 offset:256
    ds_read_b64_tr_b16 v[42:43], v10 offset:256
    ds_read_b64_tr_b16 v[44:45], v4 offset:18432
    ds_read_b64_tr_b16 v[48:49], v10 offset:18432
    ds_read_b64_tr_b16 v[52:53], v11 offset:18432
    ds_read_b64_tr_b16 v[46:47], v5 offset:18944
    ds_read_b64_tr_b16 v[50:51], v11 offset:18688
    ds_read_b64_tr_b16 v[54:55], v10 offset:18688
    ds_read_b64_tr_b16 v[56:57], v4 offset:36864
    ds_read_b64_tr_b16 v[60:61], v10 offset:36864
    ds_read_b64_tr_b16 v[64:65], v11 offset:36864
    ds_read_b64_tr_b16 v[58:59], v5 offset:37376
    ds_read_b64_tr_b16 v[62:63], v11 offset:37120
    ds_read_b64_tr_b16 v[66:67], v10 offset:37120
    ds_read_b64_tr_b16 v[68:69], v6 offset:0
    ds_read_b64_tr_b16 v[72:73], v12 offset:0
    ds_read_b64_tr_b16 v[76:77], v13 offset:0
    ds_read_b64_tr_b16 v[70:71], v7 offset:512
    ds_read_b64_tr_b16 v[74:75], v13 offset:256
    ds_read_b64_tr_b16 v[78:79], v12 offset:256
    ds_read_b64_tr_b16 v[80:81], v6 offset:18432
    ds_read_b64_tr_b16 v[84:85], v12 offset:18432
    ds_read_b64_tr_b16 v[88:89], v13 offset:18432
    ds_read_b64_tr_b16 v[82:83], v7 offset:18944
    ds_read_b64_tr_b16 v[86:87], v13 offset:18688
    ds_read_b64_tr_b16 v[90:91], v12 offset:18688
    ds_read_b64_tr_b16 v[92:93], v6 offset:36864
    ds_read_b64_tr_b16 v[96:97], v12 offset:36864
    ds_read_b64_tr_b16 v[100:101], v13 offset:36864
    ds_read_b64_tr_b16 v[94:95], v7 offset:37376
    ds_read_b64_tr_b16 v[98:99], v13 offset:37120
    ds_read_b64_tr_b16 v[102:103], v12 offset:37120
    ds_read_b64_tr_b16 v[104:105], v8 offset:0
    ds_read_b64_tr_b16 v[108:109], v14 offset:0
    ds_read_b64_tr_b16 v[112:113], v15 offset:0
    ds_read_b64_tr_b16 v[106:107], v9 offset:512
    ds_read_b64_tr_b16 v[110:111], v15 offset:256
    ds_read_b64_tr_b16 v[114:115], v14 offset:256
    ds_read_b64_tr_b16 v[116:117], v8 offset:18432
    ds_read_b64_tr_b16 v[120:121], v14 offset:18432
    ds_read_b64_tr_b16 v[124:125], v15 offset:18432
    ds_read_b64_tr_b16 v[118:119], v9 offset:18944
    ds_read_b64_tr_b16 v[122:123], v15 offset:18688
    ds_read_b64_tr_b16 v[126:127], v14 offset:18688
    s_waitcnt lgkmcnt(15)
    v_mfma_f32_16x16x32_bf16 v[24:27], v[32:35], v[36:39], 0
    s_waitcnt lgkmcnt(15)
    v_mfma_f32_16x16x32_bf16 v[28:31], v[32:35], v[40:43], 0
    s_waitcnt lgkmcnt(15)
    v_mfma_f32_16x16x32_bf16 v[24:27], v[44:47], v[48:51], v[24:27]
    s_waitcnt lgkmcnt(15)
    v_mfma_f32_16x16x32_bf16 v[28:31], v[44:47], v[52:55], v[28:31]
    s_waitcnt lgkmcnt(15)
    v_mfma_f32_16x16x32_bf16 v[24:27], v[56:59], v[60:63], v[24:27]
    s_waitcnt lgkmcnt(15)
    v_mfma_f32_16x16x32_bf16 v[28:31], v[56:59], v[64:67], v[28:31]
    s_waitcnt lgkmcnt(15)
    v_mfma_f32_16x16x32_bf16 v[24:27], v[68:71], v[72:75], v[24:27]
    s_waitcnt lgkmcnt(15)
    v_mfma_f32_16x16x32_bf16 v[28:31], v[68:71], v[76:79], v[28:31]
    s_waitcnt lgkmcnt(15)
    v_mfma_f32_16x16x32_bf16 v[24:27], v[80:83], v[84:87], v[24:27]
    s_waitcnt lgkmcnt(15)
    v_mfma_f32_16x16x32_bf16 v[28:31], v[80:83], v[88:91], v[28:31]
    s_waitcnt lgkmcnt(13)
    v_mfma_f32_16x16x32_bf16 v[24:27], v[92:95], v[96:99], v[24:27]
    s_waitcnt lgkmcnt(12)
    v_mfma_f32_16x16x32_bf16 v[28:31], v[92:95], v[100:103], v[28:31]
    s_waitcnt lgkmcnt(7)
    v_mfma_f32_16x16x32_bf16 v[24:27], v[104:107], v[108:111], v[24:27]
    s_waitcnt lgkmcnt(6)
    v_mfma_f32_16x16x32_bf16 v[28:31], v[104:107], v[112:115], v[28:31]
    s_waitcnt lgkmcnt(1)
    v_mfma_f32_16x16x32_bf16 v[24:27], v[116:119], v[120:123], v[24:27]
    s_waitcnt lgkmcnt(0)
    v_mfma_f32_16x16x32_bf16 v[28:31], v[116:119], v[124:127], v[28:31]
    s_nop 5
    buffer_store_dwordx4 v[24:27], v130, s[40:43], s78 offen sc1
    s_nop 0
    buffer_store_dwordx4 v[28:31], v131, s[40:43], s78 offen sc1
    v_mov_b32 v12, 161804
    v_mov_b32 v13, 1
    s_mov_b64 exec, 1
    ds_add_u32 v12, v13
    s_mov_b64 exec, -1
    s_setprio 0
    s_waitcnt vmcnt(2)
    v_mov_b32 v16, 161812
    v_mov_b32 v17, 1
    s_mov_b64 exec, 1
    ds_add_u32 v16, v17
    s_mov_b64 exec, -1
    s_endpgm
K_comp:
    s_lshl_b32 s74, s64, 3
    s_add_u32 s74, s74, s3
    s_mul_i32 s82, s74, 147456
    s_mul_i32 s70, s3, 12288
    s_mul_i32 s76, s86, 896
    v_cmp_gt_u32_e64 s[90:91], 56, v1
    v_mov_b32 v138, 0x7f000000
    s_nop 0
    v_cndmask_b32_e64 v138, v138, v2, s[90:91]
    s_waitcnt lgkmcnt(0)
    s_mov_b32 s24, s4
    s_mov_b32 s25, s5
    s_mov_b32 s26, 1835008
    s_mov_b32 s27, 0x20000
    buffer_load_dwordx4 v[152:155], v138, s[24:27], s76 offen
    s_mov_b32 s40, s22
    s_mov_b32 s41, s23
    s_mov_b32 s42, 20971520
    s_mov_b32 s43, 0x20000
    s_mov_b32 s44, s20
    s_mov_b32 s45, s21
    s_mov_b32 s46, 256
    s_mov_b32 s47, 0x20000
    s_mov_b32 s56, s18
    s_mov_b32 s57, s19
    s_mov_b32 s58, 1605632
    s_mov_b32 s59, 0x20000
    s_mov_b32 s60, s10
    s_mov_b32 s61, s11
    s_mov_b32 s62, 401408
    s_mov_b32 s63, 0x20000
    s_mov_b32 s30, 1835008
    s_mov_b32 s31, 0x20000
    s_lshl_b32 s74, s3, 3
    s_add_u32 s74, s74, s2
    s_cmp_ge_u32 s74, 8
    s_cbranch_scc1 K_notok
    s_memrealtime s[98:99]
    s_waitcnt lgkmcnt(0)
    s_waitcnt lgkmcnt(0)
    s_or_b32 s98, s98, 1
    s_waitcnt lgkmcnt(0)
    v_mov_b32 v26, s98
    s_lshl_b32 s74, s2, 5
    s_mov_b64 exec, 1
    buffer_store_dword v26, v3, s[44:47], s74 offen sc1
    s_mov_b64 exec, -1
K_notok:
    s_lshl_b32 s83, s83, 5
    s_add_u32 s83, s83, s82
    s_lshl_b32 s84, s84, 5
    s_add_u32 s84, s84, s82
    v_lshrrev_b32 v139, 5, v1
    v_and_b32 v141, 31, v1
    v_bfe_u32 v142, v1, 1, 3
    v_xor_b32 v142, v142, v139
    v_lshlrev_b32 v141, 7, v141
    v_lshl_add_u32 v141, v142, 4, v141
    v_add_u32 v4, s70, v141
    v_xor_b32 v5, 32, v4
    v_xor_b32 v6, 64, v4
    v_xor_b32 v7, 0x60, v4
    v_add_u32 v13, 147456, v2
    v_bfe_u32 v137, v1, 2, 2
    v_lshl_add_u32 v145, v139, 2, v137
    v_lshlrev_b32 v145, 6, v145
    v_and_b32 v146, 1, v1
    v_lshl_add_u32 v145, v146, 5, v145
    v_bfe_u32 v146, v1, 1, 1
    v_bfe_u32 v140, v1, 4, 1
    v_lshl_add_u32 v146, v140, 1, v146
    v_lshl_add_u32 v145, v146, 3, v145
    v_add_u32 v14, 159744, v145
    v_mov_b32 v145, 161792
    ds_write_b32 v145, v3
    ds_write_b32 v145, v3 offset:4
    ds_write_b32 v145, v3 offset:8
    ds_write_b32 v145, v3 offset:12
    ds_write_b32 v145, v3 offset:16
    ds_write_b32 v145, v3 offset:20
    v_lshlrev_b32 v146, 2, v1
    v_add_u32 v146, 161856, v146
    ds_write_b32 v146, v3
    s_waitcnt vmcnt(0)
    v_lshlrev_b32 v136, 16, v152
    v_and_b32 v137, 0xffff0000, v152
    v_lshlrev_b32 v138, 16, v153
    v_and_b32 v139, 0xffff0000, v153
    v_lshlrev_b32 v140, 16, v154
    v_and_b32 v141, 0xffff0000, v154
    v_lshlrev_b32 v142, 16, v155
    v_and_b32 v143, 0xffff0000, v155
    v_add_f32 v144, v136, v137
    v_add_f32 v145, v138, v139
    v_add_f32 v146, v140, v141
    v_add_f32 v147, v142, v143
    v_add_f32 v144, v144, v145
    v_add_f32 v146, v146, v147
    v_add_f32 v144, v144, v146
    s_nop 1
    v_add_f32_dpp v144, v144, v144 quad_perm:[1,0,3,2] row_mask:0xf bank_mask:0xf
    s_nop 1
    v_add_f32_dpp v144, v144, v144 quad_perm:[2,3,0,1] row_mask:0xf bank_mask:0xf
    s_nop 1
    v_add_f32_dpp v144, v144, v144 row_half_mirror row_mask:0xf bank_mask:0xf
    s_nop 1
    v_add_f32_dpp v144, v144, v144 row_mirror row_mask:0xf bank_mask:0xf
    v_mov_b32 v145, v144
    s_nop 1
    v_permlane16_swap_b32 v145, v144
    v_add_f32 v144, v144, v145
    v_mov_b32 v145, v144
    s_nop 1
    v_permlane32_swap_b32 v145, v144
    v_add_f32 v144, v144, v145
    v_mul_f32 v144, 0x3b124925, v144
    v_sub_f32 v136, v136, v144
    v_sub_f32 v137, v137, v144
    v_sub_f32 v138, v138, v144
    v_sub_f32 v139, v139, v144
    v_sub_f32 v140, v140, v144
    v_sub_f32 v141, v141, v144
    v_sub_f32 v142, v142, v144
    v_sub_f32 v143, v143, v144
    v_mul_f32 v145, v136, v136
    v_mul_f32 v146, v137, v137
    v_fmac_f32 v145, v138, v138
    v_fmac_f32 v146, v139, v139
    v_fmac_f32 v145, v140, v140
    v_fmac_f32 v146, v141, v141
    v_fmac_f32 v145, v142, v142
    v_fmac_f32 v146, v143, v143
    v_add_f32 v145, v145, v146
    v_cndmask_b32_e64 v145, 0, v145, s[90:91]
    s_nop 1
    v_add_f32_dpp v145, v145, v145 quad_perm:[1,0,3,2] row_mask:0xf bank_mask:0xf
    s_nop 1
    v_add_f32_dpp v145, v145, v145 quad_perm:[2,3,0,1] row_mask:0xf bank_mask:0xf
    s_nop 1
    v_add_f32_dpp v145, v145, v145 row_half_mirror row_mask:0xf bank_mask:0xf
    s_nop 1
    v_add_f32_dpp v145, v145, v145 row_mirror row_mask:0xf bank_mask:0xf
    v_mov_b32 v146, v145
    s_nop 1
    v_permlane16_swap_b32 v146, v145
    v_add_f32 v145, v145, v146
    v_mov_b32 v146, v145
    s_nop 1
    v_permlane32_swap_b32 v146, v145
    v_add_f32 v145, v145, v146
    v_mul_f32 v145, 0x3b124925, v145
    v_cvt_pk_bf16_f32 v145, v145, v145
    v_lshlrev_b32 v145, 16, v145
    v_add_f32 v145, 0x3727c5ac, v145
    v_cvt_pk_bf16_f32 v145, v145, v145
    v_lshlrev_b32 v145, 16, v145
    v_sqrt_f32 v145, v145
    s_nop 0
    v_cvt_pk_bf16_f32 v25, v145, v145
    v_lshlrev_b32 v25, 16, v25
    v_cvt_pk_bf16_f32 v24, -v144, -v144
    s_lshl_b32 s74, s3, 3
    s_add_u32 s74, s74, 162112
    v_mov_b32 v26, s74
    ds_write_b64 v26, v[24:25]
    s_cmp_eq_u32 s68, 1
    s_cbranch_scc1 K_kv
K_q:
    v_lshrrev_b32 v139, 5, v1
    v_bfe_u32 v140, v1, 4, 1
    v_bfe_u32 v137, v1, 2, 2
    v_and_b32 v138, 3, v1
    v_lshl_add_u32 v141, v139, 3, v137
    v_lshlrev_b32 v142, 6, v141
    v_lshl_add_u32 v144, v140, 2, v138
    v_add_u32 v144, s73, v144
    v_and_b32 v144, 7, v144
    v_lshl_add_u32 v144, v144, 3, v142
    v_add_u32 v8, 114688, v144
    v_lshrrev_b32 v142, 1, v138
    v_and_b32 v143, 2, v137
    v_xor_b32 v142, v142, v143
    v_lshl_add_u32 v142, v140, 2, v142
    v_lshlrev_b32 v143, 7, v141
    v_lshl_add_u32 v143, v142, 4, v143
    v_and_b32 v142, 1, v138
    v_lshl_add_u32 v143, v142, 3, v143
    v_lshl_add_u32 v143, v140, 13, v143
    v_add_u32 v9, 98304, v143
    v_xor_b32 v10, 32, v9
    v_xor_b32 v11, 64, v9
    v_xor_b32 v12, 0x60, v9
    s_and_b32 s74, s2, 7
    s_lshr_b32 s75, s2, 3
    s_and_b32 s76, s74, 1
    s_lshl_b32 s76, s76, 2
    s_lshr_b32 s74, s74, 1
    s_add_u32 s73, s74, s76
    s_lshl_b32 s65, s73, 2
    s_and_b32 s76, s75, 3
    s_add_u32 s65, s65, s76
    s_lshr_b32 s66, s75, 2
    s_waitcnt lgkmcnt(0)
    s_barrier
    ds_read_b128 v[28:31], v4 offset:0
    ds_read_b64_tr_b16 v[144:145], v8 offset:0
    ds_read_b64_tr_b16 v[146:147], v8 offset:256
    ds_read_b64_tr_b16 v[148:149], v9 offset:0
    ds_read_b64_tr_b16 v[150:151], v9 offset:512
    ds_read_b64_tr_b16 v[152:153], v10 offset:0
    ds_read_b64_tr_b16 v[154:155], v10 offset:512
    ds_read_b64_tr_b16 v[156:157], v11 offset:0
    ds_read_b64_tr_b16 v[158:159], v11 offset:512
    ds_read_b64_tr_b16 v[160:161], v12 offset:0
    ds_read_b64_tr_b16 v[162:163], v12 offset:512
    s_waitcnt lgkmcnt(8)
    v_mfma_f32_32x32x16_bf16 v[56:71], v[144:147], v[28:31], 0
    ds_read_b128 v[32:35], v5 offset:0
    ds_read_b64_tr_b16 v[36:37], v8 offset:1024
    ds_read_b64_tr_b16 v[38:39], v8 offset:1280
    s_waitcnt lgkmcnt(9)
    v_mfma_f32_32x32x16_bf16 v[72:87], v[148:151], v[28:31], 0
    ds_read_b64_tr_b16 v[40:41], v9 offset:2048
    ds_read_b64_tr_b16 v[42:43], v9 offset:2560
    s_waitcnt lgkmcnt(9)
    v_mfma_f32_32x32x16_bf16 v[88:103], v[152:155], v[28:31], 0
    ds_read_b64_tr_b16 v[44:45], v10 offset:2048
    ds_read_b64_tr_b16 v[46:47], v10 offset:2560
    s_waitcnt lgkmcnt(9)
    v_mfma_f32_32x32x16_bf16 v[104:119], v[156:159], v[28:31], 0
    ds_read_b64_tr_b16 v[48:49], v11 offset:2048
    ds_read_b64_tr_b16 v[50:51], v11 offset:2560
    s_waitcnt lgkmcnt(9)
    v_mfma_f32_32x32x16_bf16 v[120:135], v[160:163], v[28:31], 0
    ds_read_b64_tr_b16 v[52:53], v12 offset:2048
    ds_read_b64_tr_b16 v[54:55], v12 offset:2560
    s_waitcnt lgkmcnt(8)
    v_mfma_f32_32x32x16_bf16 v[56:71], v[36:39], v[32:35], v[56:71]
    ds_read_b128 v[28:31], v6 offset:0
    ds_read_b64_tr_b16 v[144:145], v8 offset:2048
    ds_read_b64_tr_b16 v[146:147], v8 offset:2304
    s_waitcnt lgkmcnt(9)
    v_mfma_f32_32x32x16_bf16 v[72:87], v[40:43], v[32:35], v[72:87]
    ds_read_b64_tr_b16 v[148:149], v9 offset:4096
    ds_read_b64_tr_b16 v[150:151], v9 offset:4608
    s_waitcnt lgkmcnt(9)
    v_mfma_f32_32x32x16_bf16 v[88:103], v[44:47], v[32:35], v[88:103]
    ds_read_b64_tr_b16 v[152:153], v10 offset:4096
    ds_read_b64_tr_b16 v[154:155], v10 offset:4608
    s_waitcnt lgkmcnt(9)
    v_mfma_f32_32x32x16_bf16 v[104:119], v[48:51], v[32:35], v[104:119]
    ds_read_b64_tr_b16 v[156:157], v11 offset:4096
    ds_read_b64_tr_b16 v[158:159], v11 offset:4608
    s_waitcnt lgkmcnt(9)
    v_mfma_f32_32x32x16_bf16 v[120:135], v[52:55], v[32:35], v[120:135]
    ds_read_b64_tr_b16 v[160:161], v12 offset:4096
    ds_read_b64_tr_b16 v[162:163], v12 offset:4608
    s_waitcnt lgkmcnt(8)
    v_mfma_f32_32x32x16_bf16 v[56:71], v[144:147], v[28:31], v[56:71]
    ds_read_b128 v[32:35], v7 offset:0
    ds_read_b64_tr_b16 v[36:37], v8 offset:3072
    ds_read_b64_tr_b16 v[38:39], v8 offset:3328
    s_waitcnt lgkmcnt(9)
    v_mfma_f32_32x32x16_bf16 v[72:87], v[148:151], v[28:31], v[72:87]
    ds_read_b64_tr_b16 v[40:41], v9 offset:6144
    ds_read_b64_tr_b16 v[42:43], v9 offset:6656
    s_waitcnt lgkmcnt(9)
    v_mfma_f32_32x32x16_bf16 v[88:103], v[152:155], v[28:31], v[88:103]
    ds_read_b64_tr_b16 v[44:45], v10 offset:6144
    ds_read_b64_tr_b16 v[46:47], v10 offset:6656
    s_waitcnt lgkmcnt(9)
    v_mfma_f32_32x32x16_bf16 v[104:119], v[156:159], v[28:31], v[104:119]
    ds_read_b64_tr_b16 v[48:49], v11 offset:6144
    ds_read_b64_tr_b16 v[50:51], v11 offset:6656
    s_waitcnt lgkmcnt(9)
    v_mfma_f32_32x32x16_bf16 v[120:135], v[160:163], v[28:31], v[120:135]
    ds_read_b64_tr_b16 v[52:53], v12 offset:6144
    ds_read_b64_tr_b16 v[54:55], v12 offset:6656
    s_waitcnt lgkmcnt(0)
    s_barrier
    v_mfma_f32_32x32x16_bf16 v[56:71], v[36:39], v[32:35], v[56:71]
    ds_read_b128 v[28:31], v4 offset:4096
    ds_read_b64_tr_b16 v[144:145], v8 offset:20480
    ds_read_b64_tr_b16 v[146:147], v8 offset:20736
    v_mfma_f32_32x32x16_bf16 v[72:87], v[40:43], v[32:35], v[72:87]
    ds_read_b64_tr_b16 v[148:149], v9 offset:20480
    ds_read_b64_tr_b16 v[150:151], v9 offset:20992
    v_mfma_f32_32x32x16_bf16 v[88:103], v[44:47], v[32:35], v[88:103]
    ds_read_b64_tr_b16 v[152:153], v10 offset:20480
    ds_read_b64_tr_b16 v[154:155], v10 offset:20992
    v_mfma_f32_32x32x16_bf16 v[104:119], v[48:51], v[32:35], v[104:119]
    ds_read_b64_tr_b16 v[156:157], v11 offset:20480
    ds_read_b64_tr_b16 v[158:159], v11 offset:20992
    v_mfma_f32_32x32x16_bf16 v[120:135], v[52:55], v[32:35], v[120:135]
    ds_read_b64_tr_b16 v[160:161], v12 offset:20480
    ds_read_b64_tr_b16 v[162:163], v12 offset:20992
    s_waitcnt lgkmcnt(8)
    v_mfma_f32_32x32x16_bf16 v[56:71], v[144:147], v[28:31], v[56:71]
    ds_read_b128 v[32:35], v5 offset:4096
    ds_read_b64_tr_b16 v[36:37], v8 offset:21504
    ds_read_b64_tr_b16 v[38:39], v8 offset:21760
    s_waitcnt lgkmcnt(9)
    v_mfma_f32_32x32x16_bf16 v[72:87], v[148:151], v[28:31], v[72:87]
    ds_read_b64_tr_b16 v[40:41], v9 offset:22528
    ds_read_b64_tr_b16 v[42:43], v9 offset:23040
    s_waitcnt lgkmcnt(9)
    v_mfma_f32_32x32x16_bf16 v[88:103], v[152:155], v[28:31], v[88:103]
    ds_read_b64_tr_b16 v[44:45], v10 offset:22528
    ds_read_b64_tr_b16 v[46:47], v10 offset:23040
    s_waitcnt lgkmcnt(9)
    v_mfma_f32_32x32x16_bf16 v[104:119], v[156:159], v[28:31], v[104:119]
    ds_read_b64_tr_b16 v[48:49], v11 offset:22528
    ds_read_b64_tr_b16 v[50:51], v11 offset:23040
    s_waitcnt lgkmcnt(9)
    v_mfma_f32_32x32x16_bf16 v[120:135], v[160:163], v[28:31], v[120:135]
    ds_read_b64_tr_b16 v[52:53], v12 offset:22528
    ds_read_b64_tr_b16 v[54:55], v12 offset:23040
    s_waitcnt lgkmcnt(8)
    v_mfma_f32_32x32x16_bf16 v[56:71], v[36:39], v[32:35], v[56:71]
    ds_read_b128 v[28:31], v6 offset:4096
    ds_read_b64_tr_b16 v[144:145], v8 offset:22528
    ds_read_b64_tr_b16 v[146:147], v8 offset:22784
    s_waitcnt lgkmcnt(9)
    v_mfma_f32_32x32x16_bf16 v[72:87], v[40:43], v[32:35], v[72:87]
    ds_read_b64_tr_b16 v[148:149], v9 offset:24576
    ds_read_b64_tr_b16 v[150:151], v9 offset:25088
    s_waitcnt lgkmcnt(9)
    v_mfma_f32_32x32x16_bf16 v[88:103], v[44:47], v[32:35], v[88:103]
    ds_read_b64_tr_b16 v[152:153], v10 offset:24576
    ds_read_b64_tr_b16 v[154:155], v10 offset:25088
    s_waitcnt lgkmcnt(9)
    v_mfma_f32_32x32x16_bf16 v[104:119], v[48:51], v[32:35], v[104:119]
    ds_read_b64_tr_b16 v[156:157], v11 offset:24576
    ds_read_b64_tr_b16 v[158:159], v11 offset:25088
    s_waitcnt lgkmcnt(9)
    v_mfma_f32_32x32x16_bf16 v[120:135], v[52:55], v[32:35], v[120:135]
    ds_read_b64_tr_b16 v[160:161], v12 offset:24576
    ds_read_b64_tr_b16 v[162:163], v12 offset:25088
    s_waitcnt lgkmcnt(8)
    v_mfma_f32_32x32x16_bf16 v[56:71], v[144:147], v[28:31], v[56:71]
    ds_read_b128 v[32:35], v7 offset:4096
    ds_read_b64_tr_b16 v[36:37], v8 offset:23552
    ds_read_b64_tr_b16 v[38:39], v8 offset:23808
    s_waitcnt lgkmcnt(9)
    v_mfma_f32_32x32x16_bf16 v[72:87], v[148:151], v[28:31], v[72:87]
    ds_read_b64_tr_b16 v[40:41], v9 offset:26624
    ds_read_b64_tr_b16 v[42:43], v9 offset:27136
    s_waitcnt lgkmcnt(9)
    v_mfma_f32_32x32x16_bf16 v[88:103], v[152:155], v[28:31], v[88:103]
    ds_read_b64_tr_b16 v[44:45], v10 offset:26624
    ds_read_b64_tr_b16 v[46:47], v10 offset:27136
    s_waitcnt lgkmcnt(9)
    v_mfma_f32_32x32x16_bf16 v[104:119], v[156:159], v[28:31], v[104:119]
    ds_read_b64_tr_b16 v[48:49], v11 offset:26624
    ds_read_b64_tr_b16 v[50:51], v11 offset:27136
    s_waitcnt lgkmcnt(9)
    v_mfma_f32_32x32x16_bf16 v[120:135], v[160:163], v[28:31], v[120:135]
    ds_read_b64_tr_b16 v[52:53], v12 offset:26624
    ds_read_b64_tr_b16 v[54:55], v12 offset:27136
    s_waitcnt lgkmcnt(0)
    s_barrier
    v_mfma_f32_32x32x16_bf16 v[56:71], v[36:39], v[32:35], v[56:71]
    ds_read_b128 v[28:31], v4 offset:8192
    ds_read_b64_tr_b16 v[144:145], v8 offset:40960
    ds_read_b64_tr_b16 v[146:147], v8 offset:41216
    v_mfma_f32_32x32x16_bf16 v[72:87], v[40:43], v[32:35], v[72:87]
    ds_read_b64_tr_b16 v[148:149], v9 offset:40960
    ds_read_b64_tr_b16 v[150:151], v9 offset:41472
    v_mfma_f32_32x32x16_bf16 v[88:103], v[44:47], v[32:35], v[88:103]
    ds_read_b64_tr_b16 v[152:153], v10 offset:40960
    ds_read_b64_tr_b16 v[154:155], v10 offset:41472
    v_mfma_f32_32x32x16_bf16 v[104:119], v[48:51], v[32:35], v[104:119]
    ds_read_b64_tr_b16 v[156:157], v11 offset:40960
    ds_read_b64_tr_b16 v[158:159], v11 offset:41472
    v_mfma_f32_32x32x16_bf16 v[120:135], v[52:55], v[32:35], v[120:135]
    ds_read_b64_tr_b16 v[160:161], v12 offset:40960
    ds_read_b64_tr_b16 v[162:163], v12 offset:41472
    s_waitcnt lgkmcnt(8)
    v_mfma_f32_32x32x16_bf16 v[56:71], v[144:147], v[28:31], v[56:71]
    ds_read_b128 v[32:35], v5 offset:8192
    ds_read_b64_tr_b16 v[36:37], v8 offset:41984
    ds_read_b64_tr_b16 v[38:39], v8 offset:42240
    s_waitcnt lgkmcnt(9)
    v_mfma_f32_32x32x16_bf16 v[72:87], v[148:151], v[28:31], v[72:87]
    ds_read_b64_tr_b16 v[40:41], v9 offset:43008
    ds_read_b64_tr_b16 v[42:43], v9 offset:43520
    s_waitcnt lgkmcnt(9)
    v_mfma_f32_32x32x16_bf16 v[88:103], v[152:155], v[28:31], v[88:103]
    ds_read_b64_tr_b16 v[44:45], v10 offset:43008
    ds_read_b64_tr_b16 v[46:47], v10 offset:43520
    s_waitcnt lgkmcnt(9)
    v_mfma_f32_32x32x16_bf16 v[104:119], v[156:159], v[28:31], v[104:119]
    ds_read_b64_tr_b16 v[48:49], v11 offset:43008
    ds_read_b64_tr_b16 v[50:51], v11 offset:43520
    s_waitcnt lgkmcnt(9)
    v_mfma_f32_32x32x16_bf16 v[120:135], v[160:163], v[28:31], v[120:135]
    ds_read_b64_tr_b16 v[52:53], v12 offset:43008
    ds_read_b64_tr_b16 v[54:55], v12 offset:43520
    s_waitcnt lgkmcnt(8)
    v_mfma_f32_32x32x16_bf16 v[56:71], v[36:39], v[32:35], v[56:71]
    ds_read_b128 v[28:31], v6 offset:8192
    ds_read_b64_tr_b16 v[144:145], v8 offset:43008
    ds_read_b64_tr_b16 v[146:147], v8 offset:43264
    s_waitcnt lgkmcnt(9)
    v_mfma_f32_32x32x16_bf16 v[72:87], v[40:43], v[32:35], v[72:87]
    ds_read_b64_tr_b16 v[148:149], v9 offset:45056
    ds_read_b64_tr_b16 v[150:151], v9 offset:45568
    s_waitcnt lgkmcnt(9)
    v_mfma_f32_32x32x16_bf16 v[88:103], v[44:47], v[32:35], v[88:103]
    ds_read_b64_tr_b16 v[152:153], v10 offset:45056
    ds_read_b64_tr_b16 v[154:155], v10 offset:45568
    s_waitcnt lgkmcnt(9)
    v_mfma_f32_32x32x16_bf16 v[104:119], v[48:51], v[32:35], v[104:119]
    ds_read_b64_tr_b16 v[156:157], v11 offset:45056
    ds_read_b64_tr_b16 v[158:159], v11 offset:45568
    s_waitcnt lgkmcnt(9)
    v_mfma_f32_32x32x16_bf16 v[120:135], v[52:55], v[32:35], v[120:135]
    ds_read_b64_tr_b16 v[160:161], v12 offset:45056
    ds_read_b64_tr_b16 v[162:163], v12 offset:45568
    s_waitcnt lgkmcnt(8)
    v_mfma_f32_32x32x16_bf16 v[56:71], v[144:147], v[28:31], v[56:71]
    ds_read_b128 v[32:35], v7 offset:8192
    ds_read_b64_tr_b16 v[36:37], v8 offset:44032
    ds_read_b64_tr_b16 v[38:39], v8 offset:44288
    s_waitcnt lgkmcnt(9)
    v_mfma_f32_32x32x16_bf16 v[72:87], v[148:151], v[28:31], v[72:87]
    ds_read_b64_tr_b16 v[40:41], v9 offset:47104
    ds_read_b64_tr_b16 v[42:43], v9 offset:47616
    s_waitcnt lgkmcnt(9)
    v_mfma_f32_32x32x16_bf16 v[88:103], v[152:155], v[28:31], v[88:103]
    ds_read_b64_tr_b16 v[44:45], v10 offset:47104
    ds_read_b64_tr_b16 v[46:47], v10 offset:47616
    s_waitcnt lgkmcnt(9)
    v_mfma_f32_32x32x16_bf16 v[104:119], v[156:159], v[28:31], v[104:119]
    ds_read_b64_tr_b16 v[48:49], v11 offset:47104
    ds_read_b64_tr_b16 v[50:51], v11 offset:47616
    s_waitcnt lgkmcnt(9)
    v_mfma_f32_32x32x16_bf16 v[120:135], v[160:163], v[28:31], v[120:135]
    ds_read_b64_tr_b16 v[52:53], v12 offset:47104
    ds_read_b64_tr_b16 v[54:55], v12 offset:47616
    s_waitcnt lgkmcnt(0)
    s_barrier
    v_mfma_f32_32x32x16_bf16 v[56:71], v[36:39], v[32:35], v[56:71]
    ds_read_b128 v[28:31], v4 offset:0
    ds_read_b64_tr_b16 v[144:145], v8 offset:0
    ds_read_b64_tr_b16 v[146:147], v8 offset:256
    v_mfma_f32_32x32x16_bf16 v[72:87], v[40:43], v[32:35], v[72:87]
    ds_read_b64_tr_b16 v[148:149], v9 offset:0
    ds_read_b64_tr_b16 v[150:151], v9 offset:512
    v_mfma_f32_32x32x16_bf16 v[88:103], v[44:47], v[32:35], v[88:103]
    ds_read_b64_tr_b16 v[152:153], v10 offset:0
    ds_read_b64_tr_b16 v[154:155], v10 offset:512
    v_mfma_f32_32x32x16_bf16 v[104:119], v[48:51], v[32:35], v[104:119]
    ds_read_b64_tr_b16 v[156:157], v11 offset:0
    ds_read_b64_tr_b16 v[158:159], v11 offset:512
    v_mfma_f32_32x32x16_bf16 v[120:135], v[52:55], v[32:35], v[120:135]
    ds_read_b64_tr_b16 v[160:161], v12 offset:0
    ds_read_b64_tr_b16 v[162:163], v12 offset:512
    s_waitcnt lgkmcnt(8)
    v_mfma_f32_32x32x16_bf16 v[56:71], v[144:147], v[28:31], v[56:71]
    ds_read_b128 v[32:35], v5 offset:0
    ds_read_b64_tr_b16 v[36:37], v8 offset:1024
    ds_read_b64_tr_b16 v[38:39], v8 offset:1280
    v_lshrrev_b32 v136, 3, v1
    v_and_b32 v137, 7, v1
    v_bfe_u32 v138, v1, 4, 1
    v_lshlrev_b32 v138, 2, v138
    v_xor_b32 v137, v137, v138
    s_waitcnt lgkmcnt(9)
    v_mfma_f32_32x32x16_bf16 v[72:87], v[148:151], v[28:31], v[72:87]
    ds_read_b64_tr_b16 v[40:41], v9 offset:2048
    ds_read_b64_tr_b16 v[42:43], v9 offset:2560
    s_lshl_b32 s74, s66, 7
    v_lshlrev_b32 v137, 4, v137
    v_add_u32 v137, s74, v137
    v_mul_u32_u24 v21, 896, v136
    v_add_u32 v21, v21, v137
    s_waitcnt lgkmcnt(9)
    v_mfma_f32_32x32x16_bf16 v[88:103], v[152:155], v[28:31], v[88:103]
    ds_read_b64_tr_b16 v[44:45], v10 offset:2048
    ds_read_b64_tr_b16 v[46:47], v10 offset:2560
    v_and_b32 v15, 31, v1
    v_lshlrev_b32 v15, 3, v15
    s_lshl_b32 s74, s3, 8
    s_add_u32 s74, s74, 156672
    v_add_u32 v15, s74, v15
    s_waitcnt lgkmcnt(9)
    v_mfma_f32_32x32x16_bf16 v[104:119], v[156:159], v[28:31], v[104:119]
    ds_read_b64_tr_b16 v[48:49], v11 offset:2048
    ds_read_b64_tr_b16 v[50:51], v11 offset:2560
    s_bfe_u32 s78, s3, 0x10001
    s_lshr_b32 s79, s3, 2
    v_bfe_u32 v136, v1, 2, 2
    v_lshrrev_b32 v137, 5, v1
    v_lshl_add_u32 v138, v137, 2, v136
    s_waitcnt lgkmcnt(9)
    v_mfma_f32_32x32x16_bf16 v[120:135], v[160:163], v[28:31], v[120:135]
    ds_read_b64_tr_b16 v[52:53], v12 offset:2048
    ds_read_b64_tr_b16 v[54:55], v12 offset:2560
    v_lshlrev_b32 v138, 7, v138
    v_lshrrev_b32 v136, 1, v136
    v_xor_b32 v136, s78, v136
    v_lshl_add_u32 v138, v136, 6, v138
    v_and_b32 v136, 1, v1
    s_waitcnt lgkmcnt(8)
    v_mfma_f32_32x32x16_bf16 v[56:71], v[36:39], v[32:35], v[56:71]
    ds_read_b128 v[28:31], v6 offset:0
    ds_read_b64_tr_b16 v[144:145], v8 offset:2048
    ds_read_b64_tr_b16 v[146:147], v8 offset:2304
    v_lshl_add_u32 v138, v136, 5, v138
    v_bfe_u32 v136, v1, 1, 1
    v_bfe_u32 v139, v1, 4, 1
    v_xor_b32 v139, s79, v139
    v_lshl_add_u32 v136, v139, 1, v136
    s_waitcnt lgkmcnt(9)
    v_mfma_f32_32x32x16_bf16 v[72:87], v[40:43], v[32:35], v[72:87]
    ds_read_b64_tr_b16 v[148:149], v9 offset:4096
    ds_read_b64_tr_b16 v[150:151], v9 offset:4608
    v_lshl_add_u32 v138, v136, 3, v138
    s_mul_i32 s74, s3, 18432
    v_add_u32 v22, s74, v138
    s_and_b32 s74, s3, 3
    s_lshl_b32 s74, s74, 1
    s_waitcnt lgkmcnt(9)
    v_mfma_f32_32x32x16_bf16 v[88:103], v[44:47], v[32:35], v[88:103]
    ds_read_b64_tr_b16 v[152:153], v10 offset:4096
    ds_read_b64_tr_b16 v[154:155], v10 offset:4608
    s_add_u32 s72, s74, s79
    s_mul_i32 s69, s72, 200704
    s_cmp_ge_u32 s2, 224
    s_cselect_b32 s74, 0x40000000, 0
    s_add_u32 s69, s69, s74
    s_waitcnt lgkmcnt(9)
    v_mfma_f32_32x32x16_bf16 v[104:119], v[48:51], v[32:35], v[104:119]
    ds_read_b64_tr_b16 v[156:157], v11 offset:4096
    ds_read_b64_tr_b16 v[158:159], v11 offset:4608
    s_waitcnt lgkmcnt(9)
    v_mfma_f32_32x32x16_bf16 v[120:135], v[52:55], v[32:35], v[120:135]
    ds_read_b64_tr_b16 v[160:161], v12 offset:4096
    ds_read_b64_tr_b16 v[162:163], v12 offset:4608
    s_waitcnt lgkmcnt(8)
    v_mfma_f32_32x32x16_bf16 v[56:71], v[144:147], v[28:31], v[56:71]
    ds_read_b128 v[32:35], v7 offset:0
    ds_read_b64_tr_b16 v[36:37], v8 offset:3072
    ds_read_b64_tr_b16 v[38:39], v8 offset:3328
    s_waitcnt lgkmcnt(9)
    v_mfma_f32_32x32x16_bf16 v[72:87], v[148:151], v[28:31], v[72:87]
    ds_read_b64_tr_b16 v[40:41], v9 offset:6144
    ds_read_b64_tr_b16 v[42:43], v9 offset:6656
    s_waitcnt lgkmcnt(9)
    v_mfma_f32_32x32x16_bf16 v[88:103], v[152:155], v[28:31], v[88:103]
    ds_read_b64_tr_b16 v[44:45], v10 offset:6144
    ds_read_b64_tr_b16 v[46:47], v10 offset:6656
    s_waitcnt lgkmcnt(9)
    v_mfma_f32_32x32x16_bf16 v[104:119], v[156:159], v[28:31], v[104:119]
    ds_read_b64_tr_b16 v[48:49], v11 offset:6144
    ds_read_b64_tr_b16 v[50:51], v11 offset:6656
    s_waitcnt lgkmcnt(9)
    v_mfma_f32_32x32x16_bf16 v[120:135], v[160:163], v[28:31], v[120:135]
    ds_read_b64_tr_b16 v[52:53], v12 offset:6144
    ds_read_b64_tr_b16 v[54:55], v12 offset:6656
    s_waitcnt lgkmcnt(0)
    s_barrier
    v_mfma_f32_32x32x16_bf16 v[56:71], v[36:39], v[32:35], v[56:71]
    ds_read_b128 v[28:31], v4 offset:4096
    ds_read_b64_tr_b16 v[144:145], v8 offset:20480
    ds_read_b64_tr_b16 v[146:147], v8 offset:20736
    v_mfma_f32_32x32x16_bf16 v[72:87], v[40:43], v[32:35], v[72:87]
    ds_read_b64_tr_b16 v[148:149], v9 offset:20480
    ds_read_b64_tr_b16 v[150:151], v9 offset:20992
    v_mfma_f32_32x32x16_bf16 v[88:103], v[44:47], v[32:35], v[88:103]
    ds_read_b64_tr_b16 v[152:153], v10 offset:20480
    ds_read_b64_tr_b16 v[154:155], v10 offset:20992
    v_mfma_f32_32x32x16_bf16 v[104:119], v[48:51], v[32:35], v[104:119]
    ds_read_b64_tr_b16 v[156:157], v11 offset:20480
    ds_read_b64_tr_b16 v[158:159], v11 offset:20992
    v_mfma_f32_32x32x16_bf16 v[120:135], v[52:55], v[32:35], v[120:135]
    ds_read_b64_tr_b16 v[160:161], v12 offset:20480
    ds_read_b64_tr_b16 v[162:163], v12 offset:20992
    s_waitcnt lgkmcnt(8)
    v_mfma_f32_32x32x16_bf16 v[56:71], v[144:147], v[28:31], v[56:71]
    ds_read_b128 v[32:35], v5 offset:4096
    ds_read_b64_tr_b16 v[36:37], v8 offset:21504
    ds_read_b64_tr_b16 v[38:39], v8 offset:21760
    s_waitcnt lgkmcnt(9)
    v_mfma_f32_32x32x16_bf16 v[72:87], v[148:151], v[28:31], v[72:87]
    ds_read_b64_tr_b16 v[40:41], v9 offset:22528
    ds_read_b64_tr_b16 v[42:43], v9 offset:23040
    s_waitcnt lgkmcnt(9)
    v_mfma_f32_32x32x16_bf16 v[88:103], v[152:155], v[28:31], v[88:103]
    ds_read_b64_tr_b16 v[44:45], v10 offset:22528
    ds_read_b64_tr_b16 v[46:47], v10 offset:23040
    s_waitcnt lgkmcnt(9)
    v_mfma_f32_32x32x16_bf16 v[104:119], v[156:159], v[28:31], v[104:119]
    ds_read_b64_tr_b16 v[48:49], v11 offset:22528
    ds_read_b64_tr_b16 v[50:51], v11 offset:23040
    s_waitcnt lgkmcnt(9)
    v_mfma_f32_32x32x16_bf16 v[120:135], v[160:163], v[28:31], v[120:135]
    ds_read_b64_tr_b16 v[52:53], v12 offset:22528
    ds_read_b64_tr_b16 v[54:55], v12 offset:23040
    s_waitcnt lgkmcnt(8)
    v_mfma_f32_32x32x16_bf16 v[56:71], v[36:39], v[32:35], v[56:71]
    ds_read_b128 v[28:31], v6 offset:4096
    ds_read_b64_tr_b16 v[144:145], v8 offset:22528
    ds_read_b64_tr_b16 v[146:147], v8 offset:22784
    s_waitcnt lgkmcnt(9)
    v_mfma_f32_32x32x16_bf16 v[72:87], v[40:43], v[32:35], v[72:87]
    ds_read_b64_tr_b16 v[148:149], v9 offset:24576
    ds_read_b64_tr_b16 v[150:151], v9 offset:25088
    s_waitcnt lgkmcnt(9)
    v_mfma_f32_32x32x16_bf16 v[88:103], v[44:47], v[32:35], v[88:103]
    ds_read_b64_tr_b16 v[152:153], v10 offset:24576
    ds_read_b64_tr_b16 v[154:155], v10 offset:25088
    s_waitcnt lgkmcnt(9)
    v_mfma_f32_32x32x16_bf16 v[104:119], v[48:51], v[32:35], v[104:119]
    ds_read_b64_tr_b16 v[156:157], v11 offset:24576
    ds_read_b64_tr_b16 v[158:159], v11 offset:25088
    s_waitcnt lgkmcnt(9)
    v_mfma_f32_32x32x16_bf16 v[120:135], v[52:55], v[32:35], v[120:135]
    ds_read_b64_tr_b16 v[160:161], v12 offset:24576
    ds_read_b64_tr_b16 v[162:163], v12 offset:25088
    s_waitcnt lgkmcnt(8)
    v_mfma_f32_32x32x16_bf16 v[56:71], v[144:147], v[28:31], v[56:71]
    ds_read_b128 v[32:35], v7 offset:4096
    ds_read_b64_tr_b16 v[36:37], v8 offset:23552
    ds_read_b64_tr_b16 v[38:39], v8 offset:23808
    s_waitcnt lgkmcnt(9)
    v_mfma_f32_32x32x16_bf16 v[72:87], v[148:151], v[28:31], v[72:87]
    ds_read_b64_tr_b16 v[40:41], v9 offset:26624
    ds_read_b64_tr_b16 v[42:43], v9 offset:27136
    s_waitcnt lgkmcnt(9)
    v_mfma_f32_32x32x16_bf16 v[88:103], v[152:155], v[28:31], v[88:103]
    ds_read_b64_tr_b16 v[44:45], v10 offset:26624
    ds_read_b64_tr_b16 v[46:47], v10 offset:27136
    s_waitcnt lgkmcnt(9)
    v_mfma_f32_32x32x16_bf16 v[104:119], v[156:159], v[28:31], v[104:119]
    ds_read_b64_tr_b16 v[48:49], v11 offset:26624
    ds_read_b64_tr_b16 v[50:51], v11 offset:27136
    s_waitcnt lgkmcnt(9)
    v_mfma_f32_32x32x16_bf16 v[120:135], v[160:163], v[28:31], v[120:135]
    ds_read_b64_tr_b16 v[52:53], v12 offset:26624
    ds_read_b64_tr_b16 v[54:55], v12 offset:27136
    s_waitcnt lgkmcnt(0)
    s_barrier
    v_mfma_f32_32x32x16_bf16 v[56:71], v[36:39], v[32:35], v[56:71]
    ds_read_b128 v[28:31], v4 offset:8192
    ds_read_b64_tr_b16 v[144:145], v8 offset:40960
    ds_read_b64_tr_b16 v[146:147], v8 offset:41216
    v_mfma_f32_32x32x16_bf16 v[72:87], v[40:43], v[32:35], v[72:87]
    ds_read_b64_tr_b16 v[148:149], v9 offset:40960
    ds_read_b64_tr_b16 v[150:151], v9 offset:41472
    v_mfma_f32_32x32x16_bf16 v[88:103], v[44:47], v[32:35], v[88:103]
    ds_read_b64_tr_b16 v[152:153], v10 offset:40960
    ds_read_b64_tr_b16 v[154:155], v10 offset:41472
    v_mfma_f32_32x32x16_bf16 v[104:119], v[48:51], v[32:35], v[104:119]
    ds_read_b64_tr_b16 v[156:157], v11 offset:40960
    ds_read_b64_tr_b16 v[158:159], v11 offset:41472
    v_mfma_f32_32x32x16_bf16 v[120:135], v[52:55], v[32:35], v[120:135]
    ds_read_b64_tr_b16 v[160:161], v12 offset:40960
    ds_read_b64_tr_b16 v[162:163], v12 offset:41472
    s_waitcnt lgkmcnt(8)
    v_mfma_f32_32x32x16_bf16 v[56:71], v[144:147], v[28:31], v[56:71]
    ds_read_b128 v[32:35], v5 offset:8192
    ds_read_b64_tr_b16 v[36:37], v8 offset:41984
    ds_read_b64_tr_b16 v[38:39], v8 offset:42240
    s_waitcnt lgkmcnt(9)
    v_mfma_f32_32x32x16_bf16 v[72:87], v[148:151], v[28:31], v[72:87]
    ds_read_b64_tr_b16 v[40:41], v9 offset:43008
    ds_read_b64_tr_b16 v[42:43], v9 offset:43520
    s_waitcnt lgkmcnt(9)
    v_mfma_f32_32x32x16_bf16 v[88:103], v[152:155], v[28:31], v[88:103]
    ds_read_b64_tr_b16 v[44:45], v10 offset:43008
    ds_read_b64_tr_b16 v[46:47], v10 offset:43520
    s_waitcnt lgkmcnt(9)
    v_mfma_f32_32x32x16_bf16 v[104:119], v[156:159], v[28:31], v[104:119]
    ds_read_b64_tr_b16 v[48:49], v11 offset:43008
    ds_read_b64_tr_b16 v[50:51], v11 offset:43520
    s_waitcnt lgkmcnt(9)
    v_mfma_f32_32x32x16_bf16 v[120:135], v[160:163], v[28:31], v[120:135]
    ds_read_b64_tr_b16 v[52:53], v12 offset:43008
    ds_read_b64_tr_b16 v[54:55], v12 offset:43520
    s_waitcnt lgkmcnt(8)
    v_mfma_f32_32x32x16_bf16 v[56:71], v[36:39], v[32:35], v[56:71]
    ds_read_b128 v[28:31], v6 offset:8192
    ds_read_b64_tr_b16 v[144:145], v8 offset:43008
    ds_read_b64_tr_b16 v[146:147], v8 offset:43264
    s_waitcnt lgkmcnt(9)
    v_mfma_f32_32x32x16_bf16 v[72:87], v[40:43], v[32:35], v[72:87]
    ds_read_b64_tr_b16 v[148:149], v9 offset:45056
    ds_read_b64_tr_b16 v[150:151], v9 offset:45568
    s_waitcnt lgkmcnt(9)
    v_mfma_f32_32x32x16_bf16 v[88:103], v[44:47], v[32:35], v[88:103]
    ds_read_b64_tr_b16 v[152:153], v10 offset:45056
    ds_read_b64_tr_b16 v[154:155], v10 offset:45568
    s_waitcnt lgkmcnt(9)
    v_mfma_f32_32x32x16_bf16 v[104:119], v[48:51], v[32:35], v[104:119]
    ds_read_b64_tr_b16 v[156:157], v11 offset:45056
    ds_read_b64_tr_b16 v[158:159], v11 offset:45568
    s_waitcnt lgkmcnt(9)
    v_mfma_f32_32x32x16_bf16 v[120:135], v[52:55], v[32:35], v[120:135]
    ds_read_b64_tr_b16 v[160:161], v12 offset:45056
    ds_read_b64_tr_b16 v[162:163], v12 offset:45568
    s_waitcnt lgkmcnt(8)
    v_mfma_f32_32x32x16_bf16 v[56:71], v[144:147], v[28:31], v[56:71]
    ds_read_b128 v[32:35], v7 offset:8192
    ds_read_b64_tr_b16 v[36:37], v8 offset:44032
    ds_read_b64_tr_b16 v[38:39], v8 offset:44288
    s_waitcnt lgkmcnt(9)
    v_mfma_f32_32x32x16_bf16 v[72:87], v[148:151], v[28:31], v[72:87]
    ds_read_b64_tr_b16 v[40:41], v9 offset:47104
    ds_read_b64_tr_b16 v[42:43], v9 offset:47616
    s_waitcnt lgkmcnt(9)
    v_mfma_f32_32x32x16_bf16 v[88:103], v[152:155], v[28:31], v[88:103]
    ds_read_b64_tr_b16 v[44:45], v10 offset:47104
    ds_read_b64_tr_b16 v[46:47], v10 offset:47616
    s_waitcnt lgkmcnt(9)
    v_mfma_f32_32x32x16_bf16 v[104:119], v[156:159], v[28:31], v[104:119]
    ds_read_b64_tr_b16 v[48:49], v11 offset:47104
    ds_read_b64_tr_b16 v[50:51], v11 offset:47616
    s_waitcnt lgkmcnt(9)
    v_mfma_f32_32x32x16_bf16 v[120:135], v[160:163], v[28:31], v[120:135]
    ds_read_b64_tr_b16 v[52:53], v12 offset:47104
    ds_read_b64_tr_b16 v[54:55], v12 offset:47616
    s_waitcnt lgkmcnt(0)
    s_barrier
    v_mfma_f32_32x32x16_bf16 v[56:71], v[36:39], v[32:35], v[56:71]
    ds_read_b128 v[28:31], v4 offset:0
    ds_read_b64_tr_b16 v[144:145], v8 offset:0
    ds_read_b64_tr_b16 v[146:147], v8 offset:256
    v_mfma_f32_32x32x16_bf16 v[72:87], v[40:43], v[32:35], v[72:87]
    ds_read_b64_tr_b16 v[148:149], v9 offset:0
    ds_read_b64_tr_b16 v[150:151], v9 offset:512
    v_mfma_f32_32x32x16_bf16 v[88:103], v[44:47], v[32:35], v[88:103]
    ds_read_b64_tr_b16 v[152:153], v10 offset:0
    ds_read_b64_tr_b16 v[154:155], v10 offset:512
    v_mfma_f32_32x32x16_bf16 v[104:119], v[48:51], v[32:35], v[104:119]
    ds_read_b64_tr_b16 v[156:157], v11 offset:0
    ds_read_b64_tr_b16 v[158:159], v11 offset:512
    v_mfma_f32_32x32x16_bf16 v[120:135], v[52:55], v[32:35], v[120:135]
    ds_read_b64_tr_b16 v[160:161], v12 offset:0
    ds_read_b64_tr_b16 v[162:163], v12 offset:512
    s_waitcnt lgkmcnt(8)
    v_mfma_f32_32x32x16_bf16 v[56:71], v[144:147], v[28:31], v[56:71]
    ds_read_b128 v[32:35], v5 offset:0
    ds_read_b64_tr_b16 v[36:37], v8 offset:1024
    ds_read_b64_tr_b16 v[38:39], v8 offset:1280
    s_waitcnt lgkmcnt(9)
    v_mfma_f32_32x32x16_bf16 v[72:87], v[148:151], v[28:31], v[72:87]
    ds_read_b64_tr_b16 v[40:41], v9 offset:2048
    ds_read_b64_tr_b16 v[42:43], v9 offset:2560
    s_waitcnt lgkmcnt(9)
    v_mfma_f32_32x32x16_bf16 v[88:103], v[152:155], v[28:31], v[88:103]
    ds_read_b64_tr_b16 v[44:45], v10 offset:2048
    ds_read_b64_tr_b16 v[46:47], v10 offset:2560
    s_waitcnt lgkmcnt(9)
    v_mfma_f32_32x32x16_bf16 v[104:119], v[156:159], v[28:31], v[104:119]
    ds_read_b64_tr_b16 v[48:49], v11 offset:2048
    ds_read_b64_tr_b16 v[50:51], v11 offset:2560
    s_waitcnt lgkmcnt(9)
    v_mfma_f32_32x32x16_bf16 v[120:135], v[160:163], v[28:31], v[120:135]
    ds_read_b64_tr_b16 v[52:53], v12 offset:2048
    ds_read_b64_tr_b16 v[54:55], v12 offset:2560
    s_waitcnt lgkmcnt(8)
    v_mfma_f32_32x32x16_bf16 v[56:71], v[36:39], v[32:35], v[56:71]
    ds_read_b128 v[28:31], v6 offset:0
    ds_read_b64_tr_b16 v[144:145], v8 offset:2048
    ds_read_b64_tr_b16 v[146:147], v8 offset:2304
    s_waitcnt lgkmcnt(9)
    v_mfma_f32_32x32x16_bf16 v[72:87], v[40:43], v[32:35], v[72:87]
    ds_read_b64_tr_b16 v[148:149], v9 offset:4096
    ds_read_b64_tr_b16 v[150:151], v9 offset:4608
    s_waitcnt lgkmcnt(9)
    v_mfma_f32_32x32x16_bf16 v[88:103], v[44:47], v[32:35], v[88:103]
    ds_read_b64_tr_b16 v[152:153], v10 offset:4096
    ds_read_b64_tr_b16 v[154:155], v10 offset:4608
    s_waitcnt lgkmcnt(9)
    v_mfma_f32_32x32x16_bf16 v[104:119], v[48:51], v[32:35], v[104:119]
    ds_read_b64_tr_b16 v[156:157], v11 offset:4096
    ds_read_b64_tr_b16 v[158:159], v11 offset:4608
    s_waitcnt lgkmcnt(9)
    v_mfma_f32_32x32x16_bf16 v[120:135], v[52:55], v[32:35], v[120:135]
    ds_read_b64_tr_b16 v[160:161], v12 offset:4096
    ds_read_b64_tr_b16 v[162:163], v12 offset:4608
    s_waitcnt lgkmcnt(8)
    v_mfma_f32_32x32x16_bf16 v[56:71], v[144:147], v[28:31], v[56:71]
    ds_read_b128 v[32:35], v7 offset:0
    ds_read_b64_tr_b16 v[36:37], v8 offset:3072
    ds_read_b64_tr_b16 v[38:39], v8 offset:3328
    s_waitcnt lgkmcnt(9)
    v_mfma_f32_32x32x16_bf16 v[72:87], v[148:151], v[28:31], v[72:87]
    ds_read_b64_tr_b16 v[40:41], v9 offset:6144
    ds_read_b64_tr_b16 v[42:43], v9 offset:6656
    s_waitcnt lgkmcnt(9)
    v_mfma_f32_32x32x16_bf16 v[88:103], v[152:155], v[28:31], v[88:103]
    ds_read_b64_tr_b16 v[44:45], v10 offset:6144
    ds_read_b64_tr_b16 v[46:47], v10 offset:6656
    s_waitcnt lgkmcnt(9)
    v_mfma_f32_32x32x16_bf16 v[104:119], v[156:159], v[28:31], v[104:119]
    ds_read_b64_tr_b16 v[48:49], v11 offset:6144
    ds_read_b64_tr_b16 v[50:51], v11 offset:6656
    s_waitcnt lgkmcnt(9)
    v_mfma_f32_32x32x16_bf16 v[120:135], v[160:163], v[28:31], v[120:135]
    ds_read_b64_tr_b16 v[52:53], v12 offset:6144
    ds_read_b64_tr_b16 v[54:55], v12 offset:6656
    s_waitcnt lgkmcnt(0)
    s_barrier
    ds_read_b64 v[16:17], v15
    ds_read_b128 v[144:147], v13 offset:0
    ds_read_b128 v[148:151], v13 offset:1024
    ds_read_b128 v[152:155], v13 offset:2048
    ds_read_b128 v[156:159], v13 offset:3072
    ds_read_b128 v[160:163], v13 offset:4096
    s_waitcnt lgkmcnt(5)
    v_mov_b32 v24, v16
    v_mov_b32 v25, v16
    v_mov_b32 v26, v16
    v_mov_b32 v27, v16
    v_rcp_f32 v16, v17
    v_mul_f32 v20, v17, v17
    v_mul_f32 v18, 0xc0135761, v16
    v_mul_f32 v19, v16, v16
    v_mul_f32 v19, v19, v18
    v_mul_f32 v19, 0x3d372713, v19
    v_mfma_f32_32x32x16_bf16 v[56:71], v[36:39], v[32:35], v[56:71]
    v_mfma_f32_32x32x16_bf16 v[72:87], v[40:43], v[32:35], v[72:87]
    v_mfma_f32_32x32x16_bf16 v[88:103], v[44:47], v[32:35], v[88:103]
    v_mfma_f32_32x32x16_bf16 v[104:119], v[48:51], v[32:35], v[104:119]
    v_mfma_f32_32x32x16_bf16 v[120:135], v[52:55], v[32:35], v[120:135]
    s_waitcnt lgkmcnt(4)
    v_mfma_f32_32x32x16_bf16 v[56:71], v[144:147], v[24:27], v[56:71]
    ds_read_b64_tr_b16 v[28:29], v14 offset:0
    ds_read_b64_tr_b16 v[30:31], v14 offset:512
    ds_read_b64_tr_b16 v[32:33], v14 offset:1024
    ds_read_b64_tr_b16 v[34:35], v14 offset:1536
    s_waitcnt lgkmcnt(7)
    v_mfma_f32_32x32x16_bf16 v[72:87], v[148:151], v[24:27], v[72:87]
    s_waitcnt lgkmcnt(6)
    v_mfma_f32_32x32x16_bf16 v[88:103], v[152:155], v[24:27], v[88:103]
    s_waitcnt lgkmcnt(5)
    v_mfma_f32_32x32x16_bf16 v[104:119], v[156:159], v[24:27], v[104:119]
    s_waitcnt lgkmcnt(4)
    v_mfma_f32_32x32x16_bf16 v[120:135], v[160:163], v[24:27], v[120:135]
    s_mul_i32 s70, s3, 18432
    v_mov_b32 v11, v21
    v_mov_b32 v12, v22
    v_xor_b32 v13, 64, v22
    s_and_b32 s74, s2, 7
    s_lshl_b32 s74, s74, 2
    s_add_u32 s74, s74, 162048
    v_mov_b32 v15, s74
    ds_read_b32 v15, v15
    s_waitcnt lgkmcnt(0)
    v_readfirstlane_b32 s98, v15
    v_pk_mul_f32 v[56:57], v[56:57], v[16:17] op_sel_hi:[1,0]
    v_pk_mul_f32 v[58:59], v[58:59], v[16:17] op_sel_hi:[1,0]
    v_pk_mul_f32 v[60:61], v[60:61], v[16:17] op_sel_hi:[1,0]
    v_pk_mul_f32 v[62:63], v[62:63], v[16:17] op_sel_hi:[1,0]
    v_pk_mul_f32 v[64:65], v[64:65], v[16:17] op_sel_hi:[1,0]
    v_pk_mul_f32 v[66:67], v[66:67], v[16:17] op_sel_hi:[1,0]
    v_pk_mul_f32 v[68:69], v[68:69], v[16:17] op_sel_hi:[1,0]
    v_pk_mul_f32 v[70:71], v[70:71], v[16:17] op_sel_hi:[1,0]
    v_cvt_pk_bf16_f32 v44, v56, v57
    v_cvt_pk_bf16_f32 v45, v58, v59
    v_cvt_pk_bf16_f32 v46, v60, v61
    v_cvt_pk_bf16_f32 v47, v62, v63
    v_cvt_pk_bf16_f32 v48, v64, v65
    v_cvt_pk_bf16_f32 v49, v66, v67
    v_cvt_pk_bf16_f32 v50, v68, v69
    v_cvt_pk_bf16_f32 v51, v70, v71
    v_mfma_f32_32x32x16_bf16 v[56:71], v[28:31], v[44:47], 0
    s_nop 0
    v_mfma_f32_32x32x16_bf16 v[56:71], v[32:35], v[48:51], v[56:71]
    v_pk_mul_f32 v[136:137], v[72:73], v[72:73]
    v_pk_mul_f32 v[138:139], v[74:75], v[74:75]
    v_pk_mul_f32 v[140:141], v[76:77], v[76:77]
    v_pk_mul_f32 v[142:143], v[78:79], v[78:79]
    v_pk_fma_f32 v[136:137], v[136:137], v[18:19], v[18:19] op_sel:[0,1,0] op_sel_hi:[1,1,0]
    v_pk_fma_f32 v[138:139], v[138:139], v[18:19], v[18:19] op_sel:[0,1,0] op_sel_hi:[1,1,0]
    v_pk_fma_f32 v[140:141], v[140:141], v[18:19], v[18:19] op_sel:[0,1,0] op_sel_hi:[1,1,0]
    v_pk_fma_f32 v[142:143], v[142:143], v[18:19], v[18:19] op_sel:[0,1,0] op_sel_hi:[1,1,0]
    v_pk_mul_f32 v[136:137], v[136:137], v[72:73]
    v_pk_mul_f32 v[138:139], v[138:139], v[74:75]
    v_pk_mul_f32 v[140:141], v[140:141], v[76:77]
    v_pk_mul_f32 v[142:143], v[142:143], v[78:79]
    v_exp_f32 v136, v136
    v_exp_f32 v137, v137
    v_exp_f32 v138, v138
    v_exp_f32 v139, v139
    v_exp_f32 v140, v140
    v_exp_f32 v141, v141
    v_exp_f32 v142, v142
    v_exp_f32 v143, v143
    v_pk_mul_f32 v[72:73], v[72:73], v[80:81]
    v_pk_mul_f32 v[74:75], v[74:75], v[82:83]
    v_pk_mul_f32 v[76:77], v[76:77], v[84:85]
    v_pk_mul_f32 v[78:79], v[78:79], v[86:87]
    v_pk_fma_f32 v[136:137], v[136:137], v[20:21], v[20:21] op_sel_hi:[1,0,0]
    v_pk_fma_f32 v[138:139], v[138:139], v[20:21], v[20:21] op_sel_hi:[1,0,0]
    v_pk_fma_f32 v[140:141], v[140:141], v[20:21], v[20:21] op_sel_hi:[1,0,0]
    v_pk_fma_f32 v[142:143], v[142:143], v[20:21], v[20:21] op_sel_hi:[1,0,0]
    v_rcp_f32 v136, v136
    v_rcp_f32 v137, v137
    v_rcp_f32 v138, v138
    v_rcp_f32 v139, v139
    v_rcp_f32 v140, v140
    v_rcp_f32 v141, v141
    v_rcp_f32 v142, v142
    v_rcp_f32 v143, v143
    v_pk_mul_f32 v[72:73], v[72:73], v[136:137]
    v_pk_mul_f32 v[74:75], v[74:75], v[138:139]
    v_pk_mul_f32 v[76:77], v[76:77], v[140:141]
    v_pk_mul_f32 v[78:79], v[78:79], v[142:143]
    v_cvt_pk_bf16_f32 v144, v72, v73
    v_cvt_pk_bf16_f32 v145, v74, v75
    v_cvt_pk_bf16_f32 v146, v76, v77
    v_cvt_pk_bf16_f32 v147, v78, v79
    s_add_u32 s87, s83, 0
    buffer_store_dwordx4 v[144:147], v2, s[40:43], s87 offen sc1
    v_pk_mul_f32 v[148:149], v[88:89], v[88:89]
    v_pk_mul_f32 v[150:151], v[90:91], v[90:91]
    v_pk_mul_f32 v[152:153], v[92:93], v[92:93]
    v_pk_mul_f32 v[154:155], v[94:95], v[94:95]
    v_pk_fma_f32 v[148:149], v[148:149], v[18:19], v[18:19] op_sel:[0,1,0] op_sel_hi:[1,1,0]
    v_pk_fma_f32 v[150:151], v[150:151], v[18:19], v[18:19] op_sel:[0,1,0] op_sel_hi:[1,1,0]
    v_pk_fma_f32 v[152:153], v[152:153], v[18:19], v[18:19] op_sel:[0,1,0] op_sel_hi:[1,1,0]
    v_pk_fma_f32 v[154:155], v[154:155], v[18:19], v[18:19] op_sel:[0,1,0] op_sel_hi:[1,1,0]
    v_pk_mul_f32 v[148:149], v[148:149], v[88:89]
    v_pk_mul_f32 v[150:151], v[150:151], v[90:91]
    v_pk_mul_f32 v[152:153], v[152:153], v[92:93]
    v_pk_mul_f32 v[154:155], v[154:155], v[94:95]
    v_exp_f32 v148, v148
    v_exp_f32 v149, v149
    v_exp_f32 v150, v150
    v_exp_f32 v151, v151
    v_exp_f32 v152, v152
    v_exp_f32 v153, v153
    v_exp_f32 v154, v154
    v_exp_f32 v155, v155
    v_pk_mul_f32 v[88:89], v[88:89], v[96:97]
    v_pk_mul_f32 v[90:91], v[90:91], v[98:99]
    v_pk_mul_f32 v[92:93], v[92:93], v[100:101]
    v_pk_mul_f32 v[94:95], v[94:95], v[102:103]
    v_pk_fma_f32 v[148:149], v[148:149], v[20:21], v[20:21] op_sel_hi:[1,0,0]
    v_pk_fma_f32 v[150:151], v[150:151], v[20:21], v[20:21] op_sel_hi:[1,0,0]
    v_pk_fma_f32 v[152:153], v[152:153], v[20:21], v[20:21] op_sel_hi:[1,0,0]
    v_pk_fma_f32 v[154:155], v[154:155], v[20:21], v[20:21] op_sel_hi:[1,0,0]
    v_rcp_f32 v148, v148
    v_rcp_f32 v149, v149
    v_rcp_f32 v150, v150
    v_rcp_f32 v151, v151
    v_rcp_f32 v152, v152
    v_rcp_f32 v153, v153
    v_rcp_f32 v154, v154
    v_rcp_f32 v155, v155
    v_pk_mul_f32 v[88:89], v[88:89], v[148:149]
    v_pk_mul_f32 v[90:91], v[90:91], v[150:151]
    v_pk_mul_f32 v[92:93], v[92:93], v[152:153]
    v_pk_mul_f32 v[94:95], v[94:95], v[154:155]
    v_cvt_pk_bf16_f32 v156, v88, v89
    v_cvt_pk_bf16_f32 v157, v90, v91
    v_cvt_pk_bf16_f32 v158, v92, v93
    v_cvt_pk_bf16_f32 v159, v94, v95
    s_add_u32 s87, s83, 1024
    buffer_store_dwordx4 v[156:159], v2, s[40:43], s87 offen sc1
    v_pk_mul_f32 v[136:137], v[104:105], v[104:105]
    v_pk_mul_f32 v[138:139], v[106:107], v[106:107]
    v_pk_mul_f32 v[140:141], v[108:109], v[108:109]
    v_pk_mul_f32 v[142:143], v[110:111], v[110:111]
    v_pk_fma_f32 v[136:137], v[136:137], v[18:19], v[18:19] op_sel:[0,1,0] op_sel_hi:[1,1,0]
    v_pk_fma_f32 v[138:139], v[138:139], v[18:19], v[18:19] op_sel:[0,1,0] op_sel_hi:[1,1,0]
    v_pk_fma_f32 v[140:141], v[140:141], v[18:19], v[18:19] op_sel:[0,1,0] op_sel_hi:[1,1,0]
    v_pk_fma_f32 v[142:143], v[142:143], v[18:19], v[18:19] op_sel:[0,1,0] op_sel_hi:[1,1,0]
    v_pk_mul_f32 v[136:137], v[136:137], v[104:105]
    v_pk_mul_f32 v[138:139], v[138:139], v[106:107]
    v_pk_mul_f32 v[140:141], v[140:141], v[108:109]
    v_pk_mul_f32 v[142:143], v[142:143], v[110:111]
    v_exp_f32 v136, v136
    v_exp_f32 v137, v137
    v_exp_f32 v138, v138
    v_exp_f32 v139, v139
    v_exp_f32 v140, v140
    v_exp_f32 v141, v141
    v_exp_f32 v142, v142
    v_exp_f32 v143, v143
    v_pk_mul_f32 v[104:105], v[104:105], v[112:113]
    v_pk_mul_f32 v[106:107], v[106:107], v[114:115]
    v_pk_mul_f32 v[108:109], v[108:109], v[116:117]
    v_pk_mul_f32 v[110:111], v[110:111], v[118:119]
    v_pk_fma_f32 v[136:137], v[136:137], v[20:21], v[20:21] op_sel_hi:[1,0,0]
    v_pk_fma_f32 v[138:139], v[138:139], v[20:21], v[20:21] op_sel_hi:[1,0,0]
    v_pk_fma_f32 v[140:141], v[140:141], v[20:21], v[20:21] op_sel_hi:[1,0,0]
    v_pk_fma_f32 v[142:143], v[142:143], v[20:21], v[20:21] op_sel_hi:[1,0,0]
    v_rcp_f32 v136, v136
    v_rcp_f32 v137, v137
    v_rcp_f32 v138, v138
    v_rcp_f32 v139, v139
    v_rcp_f32 v140, v140
    v_rcp_f32 v141, v141
    v_rcp_f32 v142, v142
    v_rcp_f32 v143, v143
    v_pk_mul_f32 v[104:105], v[104:105], v[136:137]
    v_pk_mul_f32 v[106:107], v[106:107], v[138:139]
    v_pk_mul_f32 v[108:109], v[108:109], v[140:141]
    v_pk_mul_f32 v[110:111], v[110:111], v[142:143]
    v_cvt_pk_bf16_f32 v144, v104, v105
    v_cvt_pk_bf16_f32 v145, v106, v107
    v_cvt_pk_bf16_f32 v146, v108, v109
    v_cvt_pk_bf16_f32 v147, v110, v111
    s_add_u32 s87, s83, 2048
    buffer_store_dwordx4 v[144:147], v2, s[40:43], s87 offen sc1
    v_pk_mul_f32 v[148:149], v[120:121], v[120:121]
    v_pk_mul_f32 v[150:151], v[122:123], v[122:123]
    v_pk_mul_f32 v[152:153], v[124:125], v[124:125]
    v_pk_mul_f32 v[154:155], v[126:127], v[126:127]
    v_pk_fma_f32 v[148:149], v[148:149], v[18:19], v[18:19] op_sel:[0,1,0] op_sel_hi:[1,1,0]
    v_pk_fma_f32 v[150:151], v[150:151], v[18:19], v[18:19] op_sel:[0,1,0] op_sel_hi:[1,1,0]
    v_pk_fma_f32 v[152:153], v[152:153], v[18:19], v[18:19] op_sel:[0,1,0] op_sel_hi:[1,1,0]
    v_pk_fma_f32 v[154:155], v[154:155], v[18:19], v[18:19] op_sel:[0,1,0] op_sel_hi:[1,1,0]
    v_pk_mul_f32 v[148:149], v[148:149], v[120:121]
    v_pk_mul_f32 v[150:151], v[150:151], v[122:123]
    v_pk_mul_f32 v[152:153], v[152:153], v[124:125]
    v_pk_mul_f32 v[154:155], v[154:155], v[126:127]
    v_exp_f32 v148, v148
    v_exp_f32 v149, v149
    v_exp_f32 v150, v150
    v_exp_f32 v151, v151
    v_exp_f32 v152, v152
    v_exp_f32 v153, v153
    v_exp_f32 v154, v154
    v_exp_f32 v155, v155
    v_pk_mul_f32 v[120:121], v[120:121], v[128:129]
    v_pk_mul_f32 v[122:123], v[122:123], v[130:131]
    v_pk_mul_f32 v[124:125], v[124:125], v[132:133]
    v_pk_mul_f32 v[126:127], v[126:127], v[134:135]
    v_pk_fma_f32 v[148:149], v[148:149], v[20:21], v[20:21] op_sel_hi:[1,0,0]
    v_pk_fma_f32 v[150:151], v[150:151], v[20:21], v[20:21] op_sel_hi:[1,0,0]
    v_pk_fma_f32 v[152:153], v[152:153], v[20:21], v[20:21] op_sel_hi:[1,0,0]
    v_pk_fma_f32 v[154:155], v[154:155], v[20:21], v[20:21] op_sel_hi:[1,0,0]
    v_rcp_f32 v148, v148
    v_rcp_f32 v149, v149
    v_rcp_f32 v150, v150
    v_rcp_f32 v151, v151
    v_rcp_f32 v152, v152
    v_rcp_f32 v153, v153
    v_rcp_f32 v154, v154
    v_rcp_f32 v155, v155
    v_pk_mul_f32 v[120:121], v[120:121], v[148:149]
    v_pk_mul_f32 v[122:123], v[122:123], v[150:151]
    v_pk_mul_f32 v[124:125], v[124:125], v[152:153]
    v_pk_mul_f32 v[126:127], v[126:127], v[154:155]
    v_cvt_pk_bf16_f32 v156, v120, v121
    v_cvt_pk_bf16_f32 v157, v122, v123
    v_cvt_pk_bf16_f32 v158, v124, v125
    v_cvt_pk_bf16_f32 v159, v126, v127
    s_add_u32 s87, s83, 3072
    buffer_store_dwordx4 v[156:159], v2, s[40:43], s87 offen sc1
    v_mov_b32 v14, 161812
K_q_a1:
    ds_read_b32 v15, v14
    s_waitcnt lgkmcnt(0)
    v_readfirstlane_b32 s75, v15
    s_nop 0
    s_cmp_lt_u32 s75, 4
    s_cbranch_scc1 K_q_a1
    ds_read_b64_tr_b16 v[72:73], v12 offset:0
    ds_read_b64_tr_b16 v[74:75], v12 offset:1024
    ds_read_b64_tr_b16 v[76:77], v13 offset:0
    ds_read_b64_tr_b16 v[78:79], v13 offset:1024
    ds_read_b64_tr_b16 v[80:81], v12 offset:2048
    ds_read_b64_tr_b16 v[82:83], v12 offset:3072
    ds_read_b64_tr_b16 v[84:85], v13 offset:2048
    ds_read_b64_tr_b16 v[86:87], v13 offset:3072
    ds_read_b64_tr_b16 v[88:89], v12 offset:4096
    ds_read_b64_tr_b16 v[90:91], v12 offset:5120
    ds_read_b64_tr_b16 v[92:93], v13 offset:4096
    ds_read_b64_tr_b16 v[94:95], v13 offset:5120
    ds_read_b64_tr_b16 v[96:97], v12 offset:6144
    ds_read_b64_tr_b16 v[98:99], v12 offset:7168
    ds_read_b64_tr_b16 v[100:101], v13 offset:6144
    ds_read_b64_tr_b16 v[102:103], v13 offset:7168
    v_cvt_pk_bf16_f32 v36, v56, v57
    v_cvt_pk_bf16_f32 v37, v58, v59
    v_cvt_pk_bf16_f32 v38, v60, v61
    v_cvt_pk_bf16_f32 v39, v62, v63
    v_cvt_pk_bf16_f32 v40, v64, v65
    v_cvt_pk_bf16_f32 v41, v66, v67
    v_cvt_pk_bf16_f32 v42, v68, v69
    v_lshlrev_b32 v56, 16, v36
    v_and_b32 v57, 0xffff0000, v36
    v_lshlrev_b32 v58, 16, v37
    v_and_b32 v59, 0xffff0000, v37
    v_lshlrev_b32 v60, 16, v38
    s_waitcnt lgkmcnt(0)
    v_and_b32 v61, 0xffff0000, v38
    v_lshlrev_b32 v62, 16, v39
    v_and_b32 v63, 0xffff0000, v39
    v_lshlrev_b32 v64, 16, v40
    v_and_b32 v65, 0xffff0000, v40
    v_lshlrev_b32 v66, 16, v41
    v_and_b32 v67, 0xffff0000, v41
    v_lshlrev_b32 v68, 16, v42
    v_and_b32 v69, 0xffff0000, v42
    v_mov_b32 v8, 0x3fb8aa3b
    v_max3_f32 v4, v56, v57, v58
    v_min3_f32 v5, v56, v57, v58
    v_max3_f32 v4, v4, v59, v60
    v_min3_f32 v5, v5, v59, v60
    s_add_u32 m0, s70, 0
    s_add_u32 s85, s69, 86016
    buffer_load_dwordx4 v11, s[56:59], s85 offen lds
    v_max3_f32 v4, v4, v61, v62
    v_min3_f32 v5, v5, v61, v62
    v_max3_f32 v4, v4, v63, v64
    v_min3_f32 v5, v5, v63, v64
    v_max3_f32 v4, v4, v65, v66
    v_min3_f32 v5, v5, v65, v66
    v_max3_f32 v4, v4, v67, v68
    v_min3_f32 v5, v5, v67, v68
    v_max_f32 v4, v4, v69
    v_min_f32 v5, v5, v69
    v_mov_b32 v6, v4
    v_mov_b32 v7, v5
    s_nop 0
    v_permlane32_swap_b32 v6, v4
    v_permlane32_swap_b32 v7, v5
    s_add_u32 m0, s70, 1024
    s_add_u32 s85, s69, 93184
    buffer_load_dwordx4 v11, s[56:59], s85 offen lds
    v_max_f32 v4, v4, v6
    v_min_f32 v5, v5, v7
    v_pk_mul_f32 v[4:5], v[4:5], v[8:9] op_sel_hi:[1,0]
    v_pk_fma_f32 v[36:37], v[56:57], v[8:9], v[4:5] op_sel_hi:[1,0,0] neg_lo:[0,0,1] neg_hi:[0,0,1]
    v_pk_fma_f32 v[38:39], v[58:59], v[8:9], v[4:5] op_sel_hi:[1,0,0] neg_lo:[0,0,1] neg_hi:[0,0,1]
    v_pk_fma_f32 v[40:41], v[60:61], v[8:9], v[4:5] op_sel_hi:[1,0,0] neg_lo:[0,0,1] neg_hi:[0,0,1]
    v_pk_fma_f32 v[42:43], v[62:63], v[8:9], v[4:5] op_sel_hi:[1,0,0] neg_lo:[0,0,1] neg_hi:[0,0,1]
    v_pk_fma_f32 v[44:45], v[64:65], v[8:9], v[4:5] op_sel_hi:[1,0,0] neg_lo:[0,0,1] neg_hi:[0,0,1]
    v_pk_fma_f32 v[46:47], v[66:67], v[8:9], v[4:5] op_sel_hi:[1,0,0] neg_lo:[0,0,1] neg_hi:[0,0,1]
    v_pk_fma_f32 v[48:49], v[68:69], v[8:9], v[4:5] op_sel_hi:[1,0,0] neg_lo:[0,0,1] neg_hi:[0,0,1]
    v_pk_fma_f32 v[56:57], v[56:57], v[8:9], v[4:5] op_sel:[0,0,1] op_sel_hi:[1,0,1] neg_lo:[1,0,0] neg_hi:[1,0,0]
    v_pk_fma_f32 v[58:59], v[58:59], v[8:9], v[4:5] op_sel:[0,0,1] op_sel_hi:[1,0,1] neg_lo:[1,0,0] neg_hi:[1,0,0]
    v_pk_fma_f32 v[60:61], v[60:61], v[8:9], v[4:5] op_sel:[0,0,1] op_sel_hi:[1,0,1] neg_lo:[1,0,0] neg_hi:[1,0,0]
    v_pk_fma_f32 v[62:63], v[62:63], v[8:9], v[4:5] op_sel:[0,0,1] op_sel_hi:[1,0,1] neg_lo:[1,0,0] neg_hi:[1,0,0]
    s_add_u32 m0, s70, 2048
    s_add_u32 s85, s69, 100352
    buffer_load_dwordx4 v11, s[56:59], s85 offen lds
    v_pk_fma_f32 v[64:65], v[64:65], v[8:9], v[4:5] op_sel:[0,0,1] op_sel_hi:[1,0,1] neg_lo:[1,0,0] neg_hi:[1,0,0]
    v_pk_fma_f32 v[66:67], v[66:67], v[8:9], v[4:5] op_sel:[0,0,1] op_sel_hi:[1,0,1] neg_lo:[1,0,0] neg_hi:[1,0,0]
    v_pk_fma_f32 v[68:69], v[68:69], v[8:9], v[4:5] op_sel:[0,0,1] op_sel_hi:[1,0,1] neg_lo:[1,0,0] neg_hi:[1,0,0]
    v_exp_f32 v36, v36
    v_exp_f32 v37, v37
    v_exp_f32 v38, v38
    v_exp_f32 v39, v39
    v_exp_f32 v40, v40
    v_exp_f32 v41, v41
    v_exp_f32 v42, v42
    v_exp_f32 v43, v43
    v_exp_f32 v44, v44
    v_exp_f32 v45, v45
    v_exp_f32 v46, v46
    s_add_u32 m0, s70, 3072
    s_add_u32 s85, s69, 107520
    buffer_load_dwordx4 v11, s[56:59], s85 offen lds
    v_exp_f32 v47, v47
    v_exp_f32 v48, v48
    v_exp_f32 v49, v49
    v_exp_f32 v56, v56
    v_exp_f32 v57, v57
    v_exp_f32 v58, v58
    v_exp_f32 v59, v59
    v_exp_f32 v60, v60
    v_exp_f32 v61, v61
    v_exp_f32 v62, v62
    v_exp_f32 v63, v63
    v_exp_f32 v64, v64
    v_exp_f32 v65, v65
    v_exp_f32 v66, v66
    s_waitcnt vmcnt(4)
    v_mov_b32 v104, 161800
    v_mov_b32 v105, 1
    s_mov_b64 exec, 1
    ds_add_rtn_u32 v106, v104, v105
    s_mov_b64 exec, -1
    s_waitcnt lgkmcnt(0)
    v_readfirstlane_b32 s75, v106
    s_nop 0
    s_cmp_lg_u32 s75, 7
    s_cbranch_scc1 K_q_nosigh
    s_and_b32 s75, s64, 3
    s_lshl_b32 s75, s75, 1
    s_lshr_b32 s76, s64, 2
    s_add_u32 s75, s75, s76
    s_mul_i32 s75, s75, 4352
    s_bfe_u32 s76, s86, 0x50003
    s_lshl_b32 s76, s76, 2
    s_add_u32 s75, s75, s76
    s_add_u32 s75, s75, 14680064
    v_mul_u32_u24 v106, 34816, v1
    v_mov_b32 v105, s98
    s_mov_b64 exec, 0xfffffff
    s_nop 1
    buffer_store_dword v105, v106, s[40:43], s75 offen sc1
    s_mov_b64 exec, -1
K_q_nosigh:
    v_exp_f32 v67, v67
    v_exp_f32 v68, v68
    v_exp_f32 v69, v69
    v_pk_add_f32 v[4:5], v[36:37], v[38:39]
    v_pk_add_f32 v[6:7], v[56:57], v[58:59]
    v_pk_add_f32 v[4:5], v[4:5], v[40:41]
    v_pk_add_f32 v[6:7], v[6:7], v[60:61]
    v_pk_add_f32 v[4:5], v[4:5], v[42:43]
    v_pk_add_f32 v[6:7], v[6:7], v[62:63]
    v_pk_add_f32 v[4:5], v[4:5], v[44:45]
    v_pk_add_f32 v[6:7], v[6:7], v[64:65]
    v_pk_add_f32 v[4:5], v[4:5], v[46:47]
    v_pk_add_f32 v[6:7], v[6:7], v[66:67]
    v_pk_add_f32 v[4:5], v[4:5], v[48:49]
    s_add_u32 m0, s70, 4096
    s_add_u32 s85, s69, 114688
    buffer_load_dwordx4 v11, s[56:59], s85 offen lds
    v_pk_add_f32 v[6:7], v[6:7], v[68:69]
    v_add_f32 v4, v4, v5
    v_add_f32 v5, v6, v7
    v_mov_b32 v6, v4
    v_mov_b32 v7, v5
    s_nop 0
    v_permlane32_swap_b32 v6, v4
    v_permlane32_swap_b32 v7, v5
    v_pk_add_f32 v[4:5], v[4:5], v[6:7]
    v_rcp_f32 v4, v4
    v_rcp_f32 v5, v5
    s_nop 0
    v_pk_mul_f32 v[36:37], v[36:37], v[4:5] op_sel_hi:[1,0]
    v_pk_mul_f32 v[38:39], v[38:39], v[4:5] op_sel_hi:[1,0]
    v_pk_mul_f32 v[40:41], v[40:41], v[4:5] op_sel_hi:[1,0]
    v_pk_mul_f32 v[42:43], v[42:43], v[4:5] op_sel_hi:[1,0]
    s_add_u32 m0, s70, 5120
    s_add_u32 s85, s69, 121856
    buffer_load_dwordx4 v11, s[56:59], s85 offen lds
    v_pk_mul_f32 v[44:45], v[44:45], v[4:5] op_sel_hi:[1,0]
    v_pk_mul_f32 v[46:47], v[46:47], v[4:5] op_sel_hi:[1,0]
    v_pk_mul_f32 v[48:49], v[48:49], v[4:5] op_sel_hi:[1,0]
    v_pk_mul_f32 v[56:57], v[56:57], v[4:5] op_sel:[0,1]
    v_pk_mul_f32 v[58:59], v[58:59], v[4:5] op_sel:[0,1]
    v_pk_mul_f32 v[60:61], v[60:61], v[4:5] op_sel:[0,1]
    v_pk_mul_f32 v[62:63], v[62:63], v[4:5] op_sel:[0,1]
    v_pk_mul_f32 v[64:65], v[64:65], v[4:5] op_sel:[0,1]
    v_pk_mul_f32 v[66:67], v[66:67], v[4:5] op_sel:[0,1]
    v_pk_mul_f32 v[68:69], v[68:69], v[4:5] op_sel:[0,1]
    v_cvt_pk_bf16_f32 v36, v36, v37
    v_cvt_pk_bf16_f32 v37, v38, v39
    v_cvt_pk_bf16_f32 v38, v40, v41
    v_cvt_pk_bf16_f32 v39, v42, v43
    s_add_u32 m0, s70, 6144
    s_add_u32 s85, s69, 129024
    buffer_load_dwordx4 v11, s[56:59], s85 offen lds
    v_cvt_pk_bf16_f32 v40, v44, v45
    v_cvt_pk_bf16_f32 v41, v46, v47
    v_cvt_pk_bf16_f32 v42, v48, v49
    v_cvt_pk_bf16_f32 v44, v56, v57
    v_cvt_pk_bf16_f32 v45, v58, v59
    v_cvt_pk_bf16_f32 v46, v60, v61
    v_cvt_pk_bf16_f32 v47, v62, v63
    v_cvt_pk_bf16_f32 v48, v64, v65
    v_cvt_pk_bf16_f32 v49, v66, v67
    v_cvt_pk_bf16_f32 v50, v68, v69
    v_mov_b32 v43, 0
    v_mov_b32 v51, 0
    s_add_u32 m0, s70, 7168
    s_add_u32 s85, s69, 136192
    buffer_load_dwordx4 v11, s[56:59], s85 offen lds
    s_add_u32 s74, s70, 12288
    v_add_u32 v9, s74, v2
    ds_write_b128 v9, v[36:39] offset:0
    ds_write_b128 v9, v[40:43] offset:1024
    ds_write_b128 v9, v[44:47] offset:2048
    ds_write_b128 v9, v[48:51] offset:3072
    ds_read_b64_tr_b16 v[56:57], v12 offset:8192
    ds_read_b64_tr_b16 v[58:59], v12 offset:9216
    ds_read_b64_tr_b16 v[60:61], v13 offset:8192
    ds_read_b64_tr_b16 v[62:63], v13 offset:9216
    ds_read_b64_tr_b16 v[64:65], v12 offset:10240
    ds_read_b64_tr_b16 v[66:67], v12 offset:11264
    ds_read_b64_tr_b16 v[68:69], v13 offset:10240
    ds_read_b64_tr_b16 v[70:71], v13 offset:11264
    s_waitcnt lgkmcnt(0)
    s_barrier
    v_lshrrev_b32 v16, 3, v1
    v_mul_u32_u24 v17, 896, v16
    v_sub_u32 v17, v11, v17
    v_lshrrev_b32 v18, 2, v16
    v_and_b32 v19, 3, v16
    v_mad_u32_u24 v18, v18, 14, v19
    v_mul_u32_u24 v4, 896, v18
    v_add_u32 v4, v4, v17
    v_cmp_lt_u32_e64 s[88:89], 1, v19
    v_mov_b32 v18, 0x7f000000
    s_nop 0
    v_cndmask_b32_e64 v5, v4, v18, s[88:89]
    s_and_b32 s77, s3, 1
    s_bfe_u32 s78, s3, 0x10001
    s_lshr_b32 s79, s3, 2
    s_lshl_b32 s74, s65, 1
    s_add_u32 s74, s74, s77
    s_mul_i32 s75, s74, 147456
    v_add_u32 v6, s75, v2
    s_xor_b32 s76, s74, 1
    s_mul_i32 s76, s76, 147456
    v_add_u32 v7, s76, v2
    v_mov_b32 v9, s75
    v_mov_b32 v10, s76
    v_cmp_lt_u32_e64 s[88:89], 15, v1
    s_nop 1
    v_cndmask_b32_e64 v9, v9, v10, s[88:89]
    v_and_b32 v10, 3, v1
    v_lshl_add_u32 v9, v10, 10, v9
    v_lshrrev_b32 v17, 5, v1
    v_and_b32 v16, 31, v1
    s_lshl_b32 s74, s74, 5
    v_add_u32 v16, s74, v16
    v_mul_u32_u24 v16, 896, v16
    v_lshlrev_b32 v17, 5, v17
    s_lshl_b32 s74, s66, 7
    s_lshl_b32 s75, s78, 6
    s_add_u32 s74, s74, s75
    s_lshl_b32 s75, s79, 4
    s_add_u32 s74, s74, s75
    v_add3_u32 v8, v16, v17, s74
    s_mul_i32 s71, s72, 50176
    s_mul_i32 s83, s72, 14336
    s_lshl_b32 s84, s72, 12
    s_add_u32 s84, s84, 100352
    s_add_u32 s87, s84, 15344
    v_mov_b32 v16, 161804
K_q_zone:
    ds_read_b32 v17, v16
    s_waitcnt lgkmcnt(0)
    v_readfirstlane_b32 s75, v17
    s_nop 0
    s_cmp_lt_u32 s75, 4
    s_cbranch_scc1 K_q_zone
    s_add_u32 m0, s70, 8192
    s_add_u32 s85, s69, 143360
    buffer_load_dwordx4 v11, s[56:59], s85 offen lds
    s_add_u32 m0, s70, 9216
    s_add_u32 s85, s69, 150528
    buffer_load_dwordx4 v11, s[56:59], s85 offen lds
    s_add_u32 m0, s70, 10240
    s_add_u32 s85, s69, 157696
    buffer_load_dwordx4 v11, s[56:59], s85 offen lds
    s_add_u32 m0, s70, 11264
    s_add_u32 s85, s69, 164864
    buffer_load_dwordx4 v11, s[56:59], s85 offen lds
    s_and_b32 s74, s72, 6
    s_lshr_b32 s75, s73, 2
    s_add_u32 s74, s74, s75
    s_lshl_b32 s74, s74, 2
    s_add_u32 s74, s74, 162048
    v_mov_b32 v24, s74
    ds_read_b32 v24, v24
    s_waitcnt lgkmcnt(0)
    v_readfirstlane_b32 s54, v24
    s_mul_i32 s52, s2, 4352
    s_add_u32 s52, s52, 14680064
    s_lshr_b32 s74, s72, 1
    s_lshl_b32 s74, s74, 3
    s_cmp_lt_u32 s3, 4
    s_movk_i32 s53, 0xff
    s_cselect_b32 s53, 0x55, s53
    s_lshl_b32 s53, s53, s74
    s_mov_b32 s77, 0
    v_min_u32 v24, 32, v1
    v_lshlrev_b32 v24, 2, v24
    v_add_u32 v25, 161856, v24
    v_and_b32 v24, 0x7c, v24
    s_add_u32 m0, s70, 12288
    s_add_u32 s85, s69, 172032
    buffer_load_dwordx4 v11, s[56:59], s85 offen lds
    s_add_u32 m0, s70, 13312
    s_add_u32 s85, s69, 179200
    buffer_load_dwordx4 v11, s[56:59], s85 offen lds
    s_add_u32 m0, s70, 14336
    s_add_u32 s85, s69, 186368
    buffer_load_dwordx4 v11, s[56:59], s85 offen lds
    s_add_u32 m0, s70, 15360
    s_add_u32 s85, s69, 193536
    buffer_load_dwordx4 v11, s[56:59], s85 offen lds
    s_add_u32 m0, s70, 16384
    s_add_u32 s85, s71, 0
    buffer_load_dwordx4 v4, s[60:63], s85 offen lds
    s_add_u32 m0, s70, 17408
    s_add_u32 s85, s71, 3584
    buffer_load_dwordx4 v4, s[60:63], s85 offen lds
    s_mov_b32 s77, 0
    s_cmp_eq_u32 s3, 7
    s_cbranch_scc1 K_q_phg
K_q_phl:
    ds_read_b32 v14, v25
    s_waitcnt lgkmcnt(0)
    s_waitcnt lgkmcnt(0)
    v_cmp_ne_u32_e64 s[88:89], s54, v14
    s_waitcnt lgkmcnt(0)
    v_readlane_b32 s75, v14, 32
    s_nop 0
    s_and_b32 s85, s88, s53
    s_cbranch_scc0 K_q_phok
    s_sleep 2
    s_nop 0
    s_cmp_eq_u32 s75, 0
    s_cbranch_scc1 K_q_phl
K_q_phg:
    s_waitcnt lgkmcnt(0)
    buffer_load_dword v14, v24, s[40:43], s52 offen sc1
    s_waitcnt vmcnt(0)
    s_mov_b32 exec_hi, 0
    s_waitcnt vmcnt(0) lgkmcnt(0)
    ds_write_b32 v25, v14
    s_mov_b32 exec_hi, -1
    s_waitcnt vmcnt(0) lgkmcnt(0)
    v_cmp_ne_u32_e64 s[88:89], s54, v14
    s_add_u32 s77, s77, 1
    s_nop 0
    s_and_b32 s85, s88, s53
    s_cbranch_scc0 K_q_phd
    s_sleep 4
    s_cmp_lt_u32 s77, 0x8000
    s_cbranch_scc1 K_q_phg
K_q_phd:
    s_waitcnt vmcnt(0) lgkmcnt(0)
    v_mov_b32 v14, 161984
    v_mov_b32 v15, 1
    s_waitcnt vmcnt(0) lgkmcnt(0)
    ds_write_b32 v14, v15
K_q_phok:
    s_add_u32 s85, s83, 0
    buffer_load_dwordx4 v[16:19], v6, s[40:43], s85 offen sc1
    buffer_load_dwordx4 v[20:23], v7, s[40:43], s85 offen sc1
    s_add_u32 s85, s83, 1024
    buffer_load_dwordx4 v[24:27], v6, s[40:43], s85 offen sc1
    buffer_load_dwordx4 v[28:31], v7, s[40:43], s85 offen sc1
    s_add_u32 s85, s83, 2048
    buffer_load_dwordx4 v[32:35], v6, s[40:43], s85 offen sc1
    buffer_load_dwordx4 v[36:39], v7, s[40:43], s85 offen sc1
    s_add_u32 s85, s83, 3072
    buffer_load_dwordx4 v[40:43], v6, s[40:43], s85 offen sc1
    buffer_load_dwordx4 v[44:47], v7, s[40:43], s85 offen sc1
    s_add_u32 s85, s83, 4096
    buffer_load_dwordx4 v[48:51], v6, s[40:43], s85 offen sc1
    buffer_load_dwordx4 v[52:55], v7, s[40:43], s85 offen sc1
    s_waitcnt vmcnt(9)
    v_mfma_f32_32x32x16_bf16 v[104:119], v[72:75], v[16:19], 0
    s_waitcnt vmcnt(8)
    v_mfma_f32_32x32x16_bf16 v[120:135], v[72:75], v[20:23], 0
    v_mfma_f32_32x32x16_bf16 v[136:151], v[76:79], v[16:19], 0
    v_mfma_f32_32x32x16_bf16 v[152:167], v[76:79], v[20:23], 0
    s_add_u32 s85, s83, 5120
    buffer_load_dwordx4 v[16:19], v6, s[40:43], s85 offen sc1
    buffer_load_dwordx4 v[20:23], v7, s[40:43], s85 offen sc1
    s_add_u32 s85, s83, 6144
    buffer_load_dwordx4 v[72:75], v6, s[40:43], s85 offen sc1
    buffer_load_dwordx4 v[76:79], v7, s[40:43], s85 offen sc1
    s_waitcnt vmcnt(11)
    v_mfma_f32_32x32x16_bf16 v[104:119], v[80:83], v[24:27], v[104:119]
    s_waitcnt vmcnt(10)
    v_mfma_f32_32x32x16_bf16 v[120:135], v[80:83], v[28:31], v[120:135]
    v_mfma_f32_32x32x16_bf16 v[136:151], v[84:87], v[24:27], v[136:151]
    v_mfma_f32_32x32x16_bf16 v[152:167], v[84:87], v[28:31], v[152:167]
    s_add_u32 s85, s83, 7168
    buffer_load_dwordx4 v[24:27], v6, s[40:43], s85 offen sc1
    buffer_load_dwordx4 v[28:31], v7, s[40:43], s85 offen sc1
    s_add_u32 s85, s83, 8192
    buffer_load_dwordx4 v[80:83], v6, s[40:43], s85 offen sc1
    buffer_load_dwordx4 v[84:87], v7, s[40:43], s85 offen sc1
    s_waitcnt vmcnt(13)
    v_mfma_f32_32x32x16_bf16 v[104:119], v[88:91], v[32:35], v[104:119]
    s_waitcnt vmcnt(12)
    v_mfma_f32_32x32x16_bf16 v[120:135], v[88:91], v[36:39], v[120:135]
    v_mfma_f32_32x32x16_bf16 v[136:151], v[92:95], v[32:35], v[136:151]
    v_mfma_f32_32x32x16_bf16 v[152:167], v[92:95], v[36:39], v[152:167]
    s_add_u32 s85, s83, 9216
    buffer_load_dwordx4 v[32:35], v6, s[40:43], s85 offen sc1
    buffer_load_dwordx4 v[36:39], v7, s[40:43], s85 offen sc1
    s_add_u32 s85, s83, 10240
    buffer_load_dwordx4 v[88:91], v6, s[40:43], s85 offen sc1
    buffer_load_dwordx4 v[92:95], v7, s[40:43], s85 offen sc1
    s_waitcnt vmcnt(15)
    v_mfma_f32_32x32x16_bf16 v[104:119], v[96:99], v[40:43], v[104:119]
    s_waitcnt vmcnt(14)
    v_mfma_f32_32x32x16_bf16 v[120:135], v[96:99], v[44:47], v[120:135]
    v_mfma_f32_32x32x16_bf16 v[136:151], v[100:103], v[40:43], v[136:151]
    v_mfma_f32_32x32x16_bf16 v[152:167], v[100:103], v[44:47], v[152:167]
    s_add_u32 s85, s83, 11264
    buffer_load_dwordx4 v[40:43], v6, s[40:43], s85 offen sc1
    buffer_load_dwordx4 v[44:47], v7, s[40:43], s85 offen sc1
    s_waitcnt vmcnt(15)
    v_mfma_f32_32x32x16_bf16 v[104:119], v[56:59], v[48:51], v[104:119]
    s_waitcnt vmcnt(14)
    v_mfma_f32_32x32x16_bf16 v[120:135], v[56:59], v[52:55], v[120:135]
    v_mfma_f32_32x32x16_bf16 v[136:151], v[60:63], v[48:51], v[136:151]
    v_mfma_f32_32x32x16_bf16 v[152:167], v[60:63], v[52:55], v[152:167]
    s_add_u32 s85, s83, 12288
    buffer_load_dwordx4 v[48:51], v6, s[40:43], s85 offen sc1
    buffer_load_dwordx4 v[52:55], v7, s[40:43], s85 offen sc1
    ds_read_b64_tr_b16 v[96:97], v12 offset:0
    ds_read_b64_tr_b16 v[98:99], v12 offset:1024
    ds_read_b64_tr_b16 v[100:101], v13 offset:0
    ds_read_b64_tr_b16 v[102:103], v13 offset:1024
    s_waitcnt vmcnt(15)
    v_mfma_f32_32x32x16_bf16 v[104:119], v[64:67], v[16:19], v[104:119]
    s_waitcnt vmcnt(14)
    v_mfma_f32_32x32x16_bf16 v[120:135], v[64:67], v[20:23], v[120:135]
    v_mfma_f32_32x32x16_bf16 v[136:151], v[68:71], v[16:19], v[136:151]
    v_mfma_f32_32x32x16_bf16 v[152:167], v[68:71], v[20:23], v[152:167]
    s_add_u32 s85, s83, 13312
    buffer_load_dwordx4 v[16:19], v6, s[40:43], s85 offen sc1
    buffer_load_dwordx4 v[20:23], v7, s[40:43], s85 offen sc1
    ds_read_b64_tr_b16 v[56:57], v12 offset:2048
    ds_read_b64_tr_b16 v[58:59], v12 offset:3072
    ds_read_b64_tr_b16 v[60:61], v13 offset:2048
    ds_read_b64_tr_b16 v[62:63], v13 offset:3072
    s_waitcnt vmcnt(15) lgkmcnt(6)
    v_mfma_f32_32x32x16_bf16 v[104:119], v[96:99], v[72:75], v[104:119]
    s_waitcnt vmcnt(14)
    v_mfma_f32_32x32x16_bf16 v[120:135], v[96:99], v[76:79], v[120:135]
    s_waitcnt lgkmcnt(4)
    v_mfma_f32_32x32x16_bf16 v[136:151], v[100:103], v[72:75], v[136:151]
    v_mfma_f32_32x32x16_bf16 v[152:167], v[100:103], v[76:79], v[152:167]
    ds_read_b64_tr_b16 v[96:97], v12 offset:4096
    ds_read_b64_tr_b16 v[98:99], v12 offset:5120
    ds_read_b64_tr_b16 v[100:101], v13 offset:4096
    ds_read_b64_tr_b16 v[102:103], v13 offset:5120
    s_waitcnt vmcnt(13) lgkmcnt(6)
    v_mfma_f32_32x32x16_bf16 v[104:119], v[56:59], v[24:27], v[104:119]
    s_waitcnt vmcnt(12)
    v_mfma_f32_32x32x16_bf16 v[120:135], v[56:59], v[28:31], v[120:135]
    s_waitcnt lgkmcnt(4)
    v_mfma_f32_32x32x16_bf16 v[136:151], v[60:63], v[24:27], v[136:151]
    v_mfma_f32_32x32x16_bf16 v[152:167], v[60:63], v[28:31], v[152:167]
    s_add_u32 m0, s70, 0
    s_add_u32 s85, s71, 7168
    buffer_load_dwordx4 v4, s[60:63], s85 offen lds
    s_add_u32 m0, s70, 1024
    s_add_u32 s85, s71, 10752
    buffer_load_dwordx4 v5, s[60:63], s85 offen lds
    ds_read_b64_tr_b16 v[56:57], v12 offset:6144
    ds_read_b64_tr_b16 v[58:59], v12 offset:7168
    ds_read_b64_tr_b16 v[60:61], v13 offset:6144
    ds_read_b64_tr_b16 v[62:63], v13 offset:7168
    s_waitcnt vmcnt(13) lgkmcnt(6)
    v_mfma_f32_32x32x16_bf16 v[104:119], v[96:99], v[80:83], v[104:119]
    s_waitcnt vmcnt(12)
    v_mfma_f32_32x32x16_bf16 v[120:135], v[96:99], v[84:87], v[120:135]
    s_waitcnt lgkmcnt(4)
    v_mfma_f32_32x32x16_bf16 v[136:151], v[100:103], v[80:83], v[136:151]
    v_mfma_f32_32x32x16_bf16 v[152:167], v[100:103], v[84:87], v[152:167]
    s_add_u32 m0, s70, 2048
    s_add_u32 s85, s71, 25088
    buffer_load_dwordx4 v4, s[60:63], s85 offen lds
    s_add_u32 m0, s70, 3072
    s_add_u32 s85, s71, 28672
    buffer_load_dwordx4 v4, s[60:63], s85 offen lds
    ds_read_b64_tr_b16 v[96:97], v12 offset:8192
    ds_read_b64_tr_b16 v[98:99], v12 offset:9216
    ds_read_b64_tr_b16 v[100:101], v13 offset:8192
    ds_read_b64_tr_b16 v[102:103], v13 offset:9216
    s_waitcnt vmcnt(13) lgkmcnt(6)
    v_mfma_f32_32x32x16_bf16 v[104:119], v[56:59], v[32:35], v[104:119]
    s_waitcnt vmcnt(12)
    v_mfma_f32_32x32x16_bf16 v[120:135], v[56:59], v[36:39], v[120:135]
    s_waitcnt lgkmcnt(4)
    v_mfma_f32_32x32x16_bf16 v[136:151], v[60:63], v[32:35], v[136:151]
    v_mfma_f32_32x32x16_bf16 v[152:167], v[60:63], v[36:39], v[152:167]
    s_add_u32 m0, s70, 4096
    s_add_u32 s85, s71, 32256
    buffer_load_dwordx4 v4, s[60:63], s85 offen lds
    s_add_u32 m0, s70, 5120
    s_add_u32 s85, s71, 35840
    buffer_load_dwordx4 v5, s[60:63], s85 offen lds
    ds_read_b64_tr_b16 v[56:57], v12 offset:10240
    ds_read_b64_tr_b16 v[58:59], v12 offset:11264
    ds_read_b64_tr_b16 v[60:61], v13 offset:10240
    ds_read_b64_tr_b16 v[62:63], v13 offset:11264
    s_waitcnt vmcnt(13) lgkmcnt(6)
    v_mfma_f32_32x32x16_bf16 v[104:119], v[96:99], v[88:91], v[104:119]
    s_waitcnt vmcnt(12)
    v_mfma_f32_32x32x16_bf16 v[120:135], v[96:99], v[92:95], v[120:135]
    s_waitcnt lgkmcnt(4)
    v_mfma_f32_32x32x16_bf16 v[136:151], v[100:103], v[88:91], v[136:151]
    v_mfma_f32_32x32x16_bf16 v[152:167], v[100:103], v[92:95], v[152:167]
    buffer_load_dword v14, v9, s[40:43], s87 offen sc1
    ds_read_b64_tr_b16 v[96:97], v12 offset:12288
    ds_read_b64_tr_b16 v[98:99], v12 offset:13312
    ds_read_b64_tr_b16 v[100:101], v13 offset:12288
    ds_read_b64_tr_b16 v[102:103], v13 offset:13312
    s_waitcnt vmcnt(12) lgkmcnt(6)
    v_mfma_f32_32x32x16_bf16 v[104:119], v[56:59], v[40:43], v[104:119]
    s_waitcnt vmcnt(11)
    v_mfma_f32_32x32x16_bf16 v[120:135], v[56:59], v[44:47], v[120:135]
    s_waitcnt lgkmcnt(4)
    v_mfma_f32_32x32x16_bf16 v[136:151], v[60:63], v[40:43], v[136:151]
    v_mfma_f32_32x32x16_bf16 v[152:167], v[60:63], v[44:47], v[152:167]
    ds_read_b64_tr_b16 v[56:57], v12 offset:14336
    ds_read_b64_tr_b16 v[58:59], v12 offset:15360
    ds_read_b64_tr_b16 v[60:61], v13 offset:14336
    ds_read_b64_tr_b16 v[62:63], v13 offset:15360
    s_waitcnt vmcnt(10) lgkmcnt(6)
    v_mfma_f32_32x32x16_bf16 v[104:119], v[96:99], v[48:51], v[104:119]
    s_waitcnt vmcnt(9)
    v_mfma_f32_32x32x16_bf16 v[120:135], v[96:99], v[52:55], v[120:135]
    s_waitcnt lgkmcnt(4)
    v_mfma_f32_32x32x16_bf16 v[136:151], v[100:103], v[48:51], v[136:151]
    v_mfma_f32_32x32x16_bf16 v[152:167], v[100:103], v[52:55], v[152:167]
    s_waitcnt vmcnt(0)
    v_cmp_eq_u32_e64 s[88:89], -1, v14
    s_mov_b32 s77, 0
    s_cmp_eq_u64 s[88:89], 0
    s_cbranch_scc1 K_q_po_ok
K_q_po_loop:
    buffer_load_dword v14, v9, s[40:43], s87 offen sc1
    s_waitcnt vmcnt(0)
    s_waitcnt vmcnt(0)
    v_cmp_eq_u32_e64 s[88:89], -1, v14
    s_add_u32 s77, s77, 1
    s_nop 0
    s_cmp_eq_u64 s[88:89], 0
    s_cbranch_scc1 K_q_po_ok
    s_sleep 4
    s_cmp_lt_u32 s77, 0x8000
    s_cbranch_scc1 K_q_po_loop
K_q_po_ok:
    s_add_u32 s85, s84, 14336
    buffer_load_dwordx4 v[64:67], v6, s[40:43], s85 offen sc1
    buffer_load_dwordx4 v[68:71], v7, s[40:43], s85 offen sc1
    s_add_u32 s85, s84, 15360
    buffer_load_dwordx4 v[72:75], v6, s[40:43], s85 offen sc1
    buffer_load_dwordx4 v[76:79], v7, s[40:43], s85 offen sc1
    s_add_u32 s85, s84, 16384
    buffer_load_dwordx4 v[24:27], v6, s[40:43], s85 offen sc1
    buffer_load_dwordx4 v[28:31], v7, s[40:43], s85 offen sc1
    s_add_u32 s85, s84, 17408
    buffer_load_dwordx4 v[80:83], v6, s[40:43], s85 offen sc1
    buffer_load_dwordx4 v[84:87], v7, s[40:43], s85 offen sc1
    ds_read_b64_tr_b16 v[96:97], v12 offset:16384
    ds_read_b64_tr_b16 v[98:99], v12 offset:17408
    ds_read_b64_tr_b16 v[100:101], v13 offset:16384
    ds_read_b64_tr_b16 v[102:103], v13 offset:17408
    s_waitcnt lgkmcnt(6)
    v_mfma_f32_32x32x16_bf16 v[104:119], v[56:59], v[16:19], v[104:119]
    v_mfma_f32_32x32x16_bf16 v[120:135], v[56:59], v[20:23], v[120:135]
    s_waitcnt lgkmcnt(4)
    v_mfma_f32_32x32x16_bf16 v[136:151], v[60:63], v[16:19], v[136:151]
    v_mfma_f32_32x32x16_bf16 v[152:167], v[60:63], v[20:23], v[152:167]
    ds_read_b64_tr_b16 v[56:57], v12 offset:0
    ds_read_b64_tr_b16 v[58:59], v12 offset:1024
    ds_read_b64_tr_b16 v[60:61], v13 offset:0
    ds_read_b64_tr_b16 v[62:63], v13 offset:1024
    s_waitcnt vmcnt(7)
    v_max3_u32 v15, v64, v65, v66
    s_waitcnt vmcnt(6)
    v_max3_u32 v15, v15, v67, v68
    v_max3_u32 v15, v15, v69, v70
    v_max_u32 v15, v15, v71
    v_cmp_eq_u32_e64 s[88:89], -1, v15
    s_nop 0
    s_cmp_eq_u64 s[88:89], 0
    s_cbranch_scc1 K_q_bok14
    s_mov_b32 s77, 0
K_q_bre14:
    s_add_u32 s85, s84, 14336
    buffer_load_dwordx4 v[64:67], v6, s[40:43], s85 offen sc1
    buffer_load_dwordx4 v[68:71], v7, s[40:43], s85 offen sc1
    s_waitcnt vmcnt(0)
    s_waitcnt vmcnt(0)
    v_max3_u32 v15, v64, v65, v66
    s_waitcnt vmcnt(0)
    v_max3_u32 v15, v15, v67, v68
    s_waitcnt vmcnt(0)
    v_max3_u32 v15, v15, v69, v70
    s_waitcnt vmcnt(0)
    v_max_u32 v15, v15, v71
    v_cmp_eq_u32_e64 s[88:89], -1, v15
    s_add_u32 s77, s77, 1
    s_nop 0
    s_cmp_eq_u64 s[88:89], 0
    s_cbranch_scc1 K_q_bok14
    s_cmp_lt_u32 s77, 0x4000
    s_cbranch_scc1 K_q_bre14
K_q_bok14:
    s_waitcnt lgkmcnt(6)
    v_mfma_f32_32x32x16_bf16 v[104:119], v[96:99], v[64:67], v[104:119]
    v_mfma_f32_32x32x16_bf16 v[120:135], v[96:99], v[68:71], v[120:135]
    s_waitcnt lgkmcnt(4)
    v_mfma_f32_32x32x16_bf16 v[136:151], v[100:103], v[64:67], v[136:151]
    v_mfma_f32_32x32x16_bf16 v[152:167], v[100:103], v[68:71], v[152:167]
    ds_read_b64_tr_b16 v[96:97], v12 offset:2048
    ds_read_b64_tr_b16 v[98:99], v12 offset:3072
    ds_read_b64_tr_b16 v[100:101], v13 offset:2048
    ds_read_b64_tr_b16 v[102:103], v13 offset:3072
    s_waitcnt vmcnt(5)
    v_max3_u32 v15, v72, v73, v74
    s_waitcnt vmcnt(4)
    v_max3_u32 v15, v15, v75, v76
    v_max3_u32 v15, v15, v77, v78
    v_max_u32 v15, v15, v79
    v_cmp_eq_u32_e64 s[88:89], -1, v15
    s_nop 0
    s_cmp_eq_u64 s[88:89], 0
    s_cbranch_scc1 K_q_bok15
    s_mov_b32 s77, 0
K_q_bre15:
    s_add_u32 s85, s84, 15360
    buffer_load_dwordx4 v[72:75], v6, s[40:43], s85 offen sc1
    buffer_load_dwordx4 v[76:79], v7, s[40:43], s85 offen sc1
    s_waitcnt vmcnt(0)
    s_waitcnt vmcnt(0)
    v_max3_u32 v15, v72, v73, v74
    s_waitcnt vmcnt(0)
    v_max3_u32 v15, v15, v75, v76
    s_waitcnt vmcnt(0)
    v_max3_u32 v15, v15, v77, v78
    s_waitcnt vmcnt(0)
    v_max_u32 v15, v15, v79
    v_cmp_eq_u32_e64 s[88:89], -1, v15
    s_add_u32 s77, s77, 1
    s_nop 0
    s_cmp_eq_u64 s[88:89], 0
    s_cbranch_scc1 K_q_bok15
    s_cmp_lt_u32 s77, 0x4000
    s_cbranch_scc1 K_q_bre15
K_q_bok15:
    s_waitcnt lgkmcnt(6)
    v_mfma_f32_32x32x16_bf16 v[104:119], v[56:59], v[72:75], v[104:119]
    v_mfma_f32_32x32x16_bf16 v[120:135], v[56:59], v[76:79], v[120:135]
    s_waitcnt lgkmcnt(4)
    v_mfma_f32_32x32x16_bf16 v[136:151], v[60:63], v[72:75], v[136:151]
    v_mfma_f32_32x32x16_bf16 v[152:167], v[60:63], v[76:79], v[152:167]
    buffer_load_dwordx4 v[88:91], v8, s[24:27], 0 offen
    ds_read_b64_tr_b16 v[56:57], v12 offset:4096
    ds_read_b64_tr_b16 v[58:59], v12 offset:5120
    ds_read_b64_tr_b16 v[60:61], v13 offset:4096
    ds_read_b64_tr_b16 v[62:63], v13 offset:5120
    s_waitcnt vmcnt(4)
    v_max3_u32 v15, v24, v25, v26
    s_waitcnt vmcnt(3)
    v_max3_u32 v15, v15, v27, v28
    v_max3_u32 v15, v15, v29, v30
    v_max_u32 v15, v15, v31
    v_cmp_eq_u32_e64 s[88:89], -1, v15
    s_nop 0
    s_cmp_eq_u64 s[88:89], 0
    s_cbranch_scc1 K_q_bok16
    s_mov_b32 s77, 0
K_q_bre16:
    s_add_u32 s85, s84, 16384
    buffer_load_dwordx4 v[24:27], v6, s[40:43], s85 offen sc1
    buffer_load_dwordx4 v[28:31], v7, s[40:43], s85 offen sc1
    s_waitcnt vmcnt(0)
    s_waitcnt vmcnt(0)
    v_max3_u32 v15, v24, v25, v26
    s_waitcnt vmcnt(0)
    v_max3_u32 v15, v15, v27, v28
    s_waitcnt vmcnt(0)
    v_max3_u32 v15, v15, v29, v30
    s_waitcnt vmcnt(0)
    v_max_u32 v15, v15, v31
    v_cmp_eq_u32_e64 s[88:89], -1, v15
    s_add_u32 s77, s77, 1
    s_nop 0
    s_cmp_eq_u64 s[88:89], 0
    s_cbranch_scc1 K_q_bok16
    s_cmp_lt_u32 s77, 0x4000
    s_cbranch_scc1 K_q_bre16
K_q_bok16:
    s_waitcnt lgkmcnt(6)
    v_mfma_f32_32x32x16_bf16 v[104:119], v[96:99], v[24:27], v[104:119]
    v_mfma_f32_32x32x16_bf16 v[120:135], v[96:99], v[28:31], v[120:135]
    s_waitcnt lgkmcnt(4)
    v_mfma_f32_32x32x16_bf16 v[136:151], v[100:103], v[24:27], v[136:151]
    v_mfma_f32_32x32x16_bf16 v[152:167], v[100:103], v[28:31], v[152:167]
    s_waitcnt vmcnt(2)
    v_max3_u32 v15, v80, v81, v82
    s_waitcnt vmcnt(1)
    v_max3_u32 v15, v15, v83, v84
    v_max3_u32 v15, v15, v85, v86
    v_max_u32 v15, v15, v87
    v_cmp_eq_u32_e64 s[88:89], -1, v15
    s_nop 0
    s_cmp_eq_u64 s[88:89], 0
    s_cbranch_scc1 K_q_bok17
    s_mov_b32 s77, 0
K_q_bre17:
    s_add_u32 s85, s84, 17408
    buffer_load_dwordx4 v[80:83], v6, s[40:43], s85 offen sc1
    buffer_load_dwordx4 v[84:87], v7, s[40:43], s85 offen sc1
    s_waitcnt vmcnt(0)
    s_waitcnt vmcnt(0)
    v_max3_u32 v15, v80, v81, v82
    s_waitcnt vmcnt(0)
    v_max3_u32 v15, v15, v83, v84
    s_waitcnt vmcnt(0)
    v_max3_u32 v15, v15, v85, v86
    s_waitcnt vmcnt(0)
    v_max_u32 v15, v15, v87
    v_cmp_eq_u32_e64 s[88:89], -1, v15
    s_add_u32 s77, s77, 1
    s_nop 0
    s_cmp_eq_u64 s[88:89], 0
    s_cbranch_scc1 K_q_bok17
    s_cmp_lt_u32 s77, 0x4000
    s_cbranch_scc1 K_q_bre17
K_q_bok17:
    s_waitcnt lgkmcnt(2)
    v_mfma_f32_32x32x16_bf16 v[104:119], v[56:59], v[80:83], v[104:119]
    v_mfma_f32_32x32x16_bf16 v[120:135], v[56:59], v[84:87], v[120:135]
    s_waitcnt lgkmcnt(0)
    v_mfma_f32_32x32x16_bf16 v[136:151], v[60:63], v[80:83], v[136:151]
    v_mfma_f32_32x32x16_bf16 v[152:167], v[60:63], v[84:87], v[152:167]
    v_add_u32 v4, s70, v2
    s_nop 7
    ds_write_b128 v4, v[120:123] offset:0
    ds_write_b128 v4, v[124:127] offset:1024
    ds_write_b128 v4, v[136:139] offset:2048
    ds_write_b128 v4, v[140:143] offset:3072
    ds_write_b128 v4, v[152:155] offset:4096
    ds_write_b128 v4, v[156:159] offset:5120
    ds_write_b128 v4, v[112:115] offset:6144
    ds_write_b128 v4, v[116:119] offset:7168
    ds_write_b128 v4, v[128:131] offset:8192
    ds_write_b128 v4, v[132:135] offset:9216
    ds_write_b128 v4, v[144:147] offset:10240
    ds_write_b128 v4, v[148:151] offset:11264
    ds_write_b128 v4, v[160:163] offset:12288
    ds_write_b128 v4, v[164:167] offset:13312
    s_xor_b32 s74, s3, 1
    s_mul_i32 s74, s74, 18432
    v_add_u32 v17, s74, v2
    s_xor_b32 s74, s3, 2
    s_mul_i32 s74, s74, 18432
    v_add_u32 v18, s74, v2
    s_xor_b32 s74, s3, 3
    s_mul_i32 s74, s74, 18432
    v_add_u32 v19, s74, v2
    s_xor_b32 s74, s3, 4
    s_mul_i32 s74, s74, 18432
    v_add_u32 v20, s74, v2
    s_xor_b32 s74, s3, 5
    s_mul_i32 s74, s74, 18432
    v_add_u32 v21, s74, v2
    s_xor_b32 s74, s3, 6
    s_mul_i32 s74, s74, 18432
    v_add_u32 v22, s74, v2
    s_xor_b32 s74, s3, 7
    s_mul_i32 s74, s74, 18432
    v_add_u32 v23, s74, v2
    s_waitcnt vmcnt(0)
    v_lshlrev_b32 v24, 16, v88
    v_and_b32 v25, 0xffff0000, v88
    v_lshlrev_b32 v26, 16, v89
    v_and_b32 v27, 0xffff0000, v89
    v_lshlrev_b32 v28, 16, v90
    v_and_b32 v29, 0xffff0000, v90
    v_lshlrev_b32 v30, 16, v91
    v_and_b32 v31, 0xffff0000, v91
    v_add_f32 v104, v104, v24
    v_add_f32 v105, v105, v25
    v_add_f32 v106, v106, v26
    v_add_f32 v107, v107, v27
    v_add_f32 v108, v108, v28
    v_add_f32 v109, v109, v29
    v_add_f32 v110, v110, v30
    v_add_f32 v111, v111, v31
    s_waitcnt lgkmcnt(0)
    s_barrier
    ds_read_b128 v[32:35], v17 offset:0
    ds_read_b128 v[36:39], v17 offset:1024
    ds_read_b128 v[40:43], v18 offset:2048
    ds_read_b128 v[44:47], v18 offset:3072
    ds_read_b128 v[48:51], v19 offset:4096
    ds_read_b128 v[52:55], v19 offset:5120
    ds_read_b128 v[56:59], v20 offset:6144
    ds_read_b128 v[60:63], v20 offset:7168
    ds_read_b128 v[64:67], v21 offset:8192
    ds_read_b128 v[68:71], v21 offset:9216
    ds_read_b128 v[72:75], v22 offset:10240
    ds_read_b128 v[76:79], v22 offset:11264
    ds_read_b128 v[80:83], v23 offset:12288
    ds_read_b128 v[84:87], v23 offset:13312
    s_waitcnt lgkmcnt(13)
    v_pk_add_f32 v[104:105], v[104:105], v[32:33]
    v_pk_add_f32 v[106:107], v[106:107], v[34:35]
    s_waitcnt lgkmcnt(12)
    v_pk_add_f32 v[108:109], v[108:109], v[36:37]
    v_pk_add_f32 v[110:111], v[110:111], v[38:39]
    s_waitcnt lgkmcnt(9)
    v_pk_add_f32 v[40:41], v[40:41], v[48:49]
    v_pk_add_f32 v[42:43], v[42:43], v[50:51]
    s_waitcnt lgkmcnt(8)
    v_pk_add_f32 v[44:45], v[44:45], v[52:53]
    v_pk_add_f32 v[46:47], v[46:47], v[54:55]
    s_waitcnt lgkmcnt(5)
    v_pk_add_f32 v[56:57], v[56:57], v[64:65]
    v_pk_add_f32 v[58:59], v[58:59], v[66:67]
    s_waitcnt lgkmcnt(4)
    v_pk_add_f32 v[60:61], v[60:61], v[68:69]
    v_pk_add_f32 v[62:63], v[62:63], v[70:71]
    s_waitcnt lgkmcnt(1)
    v_pk_add_f32 v[72:73], v[72:73], v[80:81]
    v_pk_add_f32 v[74:75], v[74:75], v[82:83]
    s_waitcnt lgkmcnt(0)
    v_pk_add_f32 v[76:77], v[76:77], v[84:85]
    v_pk_add_f32 v[78:79], v[78:79], v[86:87]
    v_pk_add_f32 v[104:105], v[104:105], v[40:41]
    v_pk_add_f32 v[106:107], v[106:107], v[42:43]
    v_pk_add_f32 v[108:109], v[108:109], v[44:45]
    v_pk_add_f32 v[110:111], v[110:111], v[46:47]
    v_pk_add_f32 v[56:57], v[56:57], v[72:73]
    v_pk_add_f32 v[58:59], v[58:59], v[74:75]
    v_pk_add_f32 v[60:61], v[60:61], v[76:77]
    v_pk_add_f32 v[62:63], v[62:63], v[78:79]
    v_pk_add_f32 v[104:105], v[104:105], v[56:57]
    v_pk_add_f32 v[106:107], v[106:107], v[58:59]
    v_pk_add_f32 v[108:109], v[108:109], v[60:61]
    v_pk_add_f32 v[110:111], v[110:111], v[62:63]
    v_cvt_pk_bf16_f32 v24, v104, v105
    v_cvt_pk_bf16_f32 v25, v106, v107
    v_cvt_pk_bf16_f32 v26, v108, v109
    v_cvt_pk_bf16_f32 v27, v110, v111
    buffer_store_dwordx4 v[24:27], v8, s[28:31], 0 offen
K_q_fin:
    s_endpgm
K_kv:
    v_lshrrev_b32 v139, 5, v1
    v_bfe_u32 v140, v1, 4, 1
    v_bfe_u32 v137, v1, 2, 2
    v_and_b32 v138, 3, v1
    v_lshl_add_u32 v141, v139, 3, v137
    v_lshlrev_b32 v142, 6, v141
    v_lshl_add_u32 v144, v140, 2, v138
    v_add_u32 v144, s73, v144
    v_and_b32 v144, 7, v144
    v_lshl_add_u32 v144, v144, 3, v142
    v_add_u32 v8, 98304, v144
    v_lshl_add_u32 v143, v138, 3, v142
    v_mul_u32_u24 v144, 1056, v140
    v_add_u32 v9, v143, v144
    v_add_u32 v9, 100352, v9
    v_xor_b32 v10, 32, v9
    v_lshlrev_b32 v142, 5, v141
    v_lshl_add_u32 v142, v138, 3, v142
    v_mul_u32_u24 v143, 2176, v140
    v_add_u32 v11, v142, v143
    v_add_u32 v11, 114688, v11
    v_xor_b32 v12, 0x80, v11
    s_and_b32 s74, s2, 7
    s_lshr_b32 s75, s2, 3
    s_and_b32 s76, s74, 1
    s_lshl_b32 s76, s76, 2
    s_lshr_b32 s74, s74, 1
    s_add_u32 s73, s74, s76
    s_lshl_b32 s65, s73, 2
    s_and_b32 s76, s75, 3
    s_add_u32 s65, s65, s76
    s_lshr_b32 s66, s75, 2
    s_waitcnt lgkmcnt(0)
    s_barrier
    ds_read_b128 v[28:31], v4 offset:0
    ds_read_b64_tr_b16 v[144:145], v8 offset:0
    ds_read_b64_tr_b16 v[146:147], v8 offset:256
    ds_read_b64_tr_b16 v[148:149], v8 offset:1024
    ds_read_b64_tr_b16 v[150:151], v8 offset:1280
    ds_read_b64_tr_b16 v[152:153], v11 offset:0
    ds_read_b64_tr_b16 v[154:155], v12 offset:0
    ds_read_b64_tr_b16 v[156:157], v9 offset:0
    ds_read_b64_tr_b16 v[158:159], v9 offset:256
    ds_read_b64_tr_b16 v[160:161], v10 offset:0
    ds_read_b64_tr_b16 v[162:163], v10 offset:256
    s_waitcnt lgkmcnt(8)
    v_mfma_f32_32x32x16_bf16 v[56:71], v[144:147], v[28:31], 0
    ds_read_b128 v[32:35], v5 offset:0
    ds_read_b64_tr_b16 v[36:37], v8 offset:4096
    ds_read_b64_tr_b16 v[38:39], v8 offset:4352
    s_waitcnt lgkmcnt(9)
    v_mfma_f32_32x32x16_bf16 v[72:87], v[148:151], v[28:31], 0
    ds_read_b64_tr_b16 v[40:41], v8 offset:5120
    ds_read_b64_tr_b16 v[42:43], v8 offset:5376
    s_waitcnt lgkmcnt(9)
    v_mfma_f32_32x32x16_bf16 v[88:103], v[152:155], v[28:31], 0
    ds_read_b64_tr_b16 v[44:45], v11 offset:512
    ds_read_b64_tr_b16 v[46:47], v12 offset:512
    s_waitcnt lgkmcnt(9)
    v_mfma_f32_32x32x16_bf16 v[104:119], v[156:159], v[28:31], 0
    ds_read_b64_tr_b16 v[48:49], v9 offset:4096
    ds_read_b64_tr_b16 v[50:51], v9 offset:4352
    s_waitcnt lgkmcnt(9)
    v_mfma_f32_32x32x16_bf16 v[120:135], v[160:163], v[28:31], 0
    ds_read_b64_tr_b16 v[52:53], v10 offset:4096
    ds_read_b64_tr_b16 v[54:55], v10 offset:4352
    s_waitcnt lgkmcnt(8)
    v_mfma_f32_32x32x16_bf16 v[56:71], v[36:39], v[32:35], v[56:71]
    ds_read_b128 v[28:31], v6 offset:0
    ds_read_b64_tr_b16 v[144:145], v8 offset:8192
    ds_read_b64_tr_b16 v[146:147], v8 offset:8448
    s_waitcnt lgkmcnt(9)
    v_mfma_f32_32x32x16_bf16 v[72:87], v[40:43], v[32:35], v[72:87]
    ds_read_b64_tr_b16 v[148:149], v8 offset:9216
    ds_read_b64_tr_b16 v[150:151], v8 offset:9472
    s_waitcnt lgkmcnt(9)
    v_mfma_f32_32x32x16_bf16 v[88:103], v[44:47], v[32:35], v[88:103]
    ds_read_b64_tr_b16 v[152:153], v11 offset:1024
    ds_read_b64_tr_b16 v[154:155], v12 offset:1024
    s_waitcnt lgkmcnt(9)
    v_mfma_f32_32x32x16_bf16 v[104:119], v[48:51], v[32:35], v[104:119]
    ds_read_b64_tr_b16 v[156:157], v9 offset:8192
    ds_read_b64_tr_b16 v[158:159], v9 offset:8448
    s_waitcnt lgkmcnt(9)
    v_mfma_f32_32x32x16_bf16 v[120:135], v[52:55], v[32:35], v[120:135]
    ds_read_b64_tr_b16 v[160:161], v10 offset:8192
    ds_read_b64_tr_b16 v[162:163], v10 offset:8448
    s_waitcnt lgkmcnt(8)
    v_mfma_f32_32x32x16_bf16 v[56:71], v[144:147], v[28:31], v[56:71]
    ds_read_b128 v[32:35], v7 offset:0
    ds_read_b64_tr_b16 v[36:37], v8 offset:12288
    ds_read_b64_tr_b16 v[38:39], v8 offset:12544
    s_waitcnt lgkmcnt(9)
    v_mfma_f32_32x32x16_bf16 v[72:87], v[148:151], v[28:31], v[72:87]
    ds_read_b64_tr_b16 v[40:41], v8 offset:13312
    ds_read_b64_tr_b16 v[42:43], v8 offset:13568
    s_waitcnt lgkmcnt(9)
    v_mfma_f32_32x32x16_bf16 v[88:103], v[152:155], v[28:31], v[88:103]
    ds_read_b64_tr_b16 v[44:45], v11 offset:1536
    ds_read_b64_tr_b16 v[46:47], v12 offset:1536
    s_waitcnt lgkmcnt(9)
    v_mfma_f32_32x32x16_bf16 v[104:119], v[156:159], v[28:31], v[104:119]
    ds_read_b64_tr_b16 v[48:49], v9 offset:12288
    ds_read_b64_tr_b16 v[50:51], v9 offset:12544
    s_waitcnt lgkmcnt(9)
    v_mfma_f32_32x32x16_bf16 v[120:135], v[160:163], v[28:31], v[120:135]
    ds_read_b64_tr_b16 v[52:53], v10 offset:12288
    ds_read_b64_tr_b16 v[54:55], v10 offset:12544
    s_waitcnt lgkmcnt(0)
    s_barrier
    v_mfma_f32_32x32x16_bf16 v[56:71], v[36:39], v[32:35], v[56:71]
    ds_read_b128 v[28:31], v4 offset:4096
    ds_read_b64_tr_b16 v[144:145], v8 offset:20480
    ds_read_b64_tr_b16 v[146:147], v8 offset:20736
    v_mfma_f32_32x32x16_bf16 v[72:87], v[40:43], v[32:35], v[72:87]
    ds_read_b64_tr_b16 v[148:149], v8 offset:21504
    ds_read_b64_tr_b16 v[150:151], v8 offset:21760
    v_mfma_f32_32x32x16_bf16 v[88:103], v[44:47], v[32:35], v[88:103]
    ds_read_b64_tr_b16 v[152:153], v11 offset:20480
    ds_read_b64_tr_b16 v[154:155], v12 offset:20480
    v_mfma_f32_32x32x16_bf16 v[104:119], v[48:51], v[32:35], v[104:119]
    ds_read_b64_tr_b16 v[156:157], v9 offset:20480
    ds_read_b64_tr_b16 v[158:159], v9 offset:20736
    v_mfma_f32_32x32x16_bf16 v[120:135], v[52:55], v[32:35], v[120:135]
    ds_read_b64_tr_b16 v[160:161], v10 offset:20480
    ds_read_b64_tr_b16 v[162:163], v10 offset:20736
    s_waitcnt lgkmcnt(8)
    v_mfma_f32_32x32x16_bf16 v[56:71], v[144:147], v[28:31], v[56:71]
    ds_read_b128 v[32:35], v5 offset:4096
    ds_read_b64_tr_b16 v[36:37], v8 offset:24576
    ds_read_b64_tr_b16 v[38:39], v8 offset:24832
    s_waitcnt lgkmcnt(9)
    v_mfma_f32_32x32x16_bf16 v[72:87], v[148:151], v[28:31], v[72:87]
    ds_read_b64_tr_b16 v[40:41], v8 offset:25600
    ds_read_b64_tr_b16 v[42:43], v8 offset:25856
    s_waitcnt lgkmcnt(9)
    v_mfma_f32_32x32x16_bf16 v[88:103], v[152:155], v[28:31], v[88:103]
    ds_read_b64_tr_b16 v[44:45], v11 offset:20992
    ds_read_b64_tr_b16 v[46:47], v12 offset:20992
    s_waitcnt lgkmcnt(9)
    v_mfma_f32_32x32x16_bf16 v[104:119], v[156:159], v[28:31], v[104:119]
    ds_read_b64_tr_b16 v[48:49], v9 offset:24576
    ds_read_b64_tr_b16 v[50:51], v9 offset:24832
    s_waitcnt lgkmcnt(9)
    v_mfma_f32_32x32x16_bf16 v[120:135], v[160:163], v[28:31], v[120:135]
    ds_read_b64_tr_b16 v[52:53], v10 offset:24576
    ds_read_b64_tr_b16 v[54:55], v10 offset:24832
    s_waitcnt lgkmcnt(8)
    v_mfma_f32_32x32x16_bf16 v[56:71], v[36:39], v[32:35], v[56:71]
    ds_read_b128 v[28:31], v6 offset:4096
    ds_read_b64_tr_b16 v[144:145], v8 offset:28672
    ds_read_b64_tr_b16 v[146:147], v8 offset:28928
    s_waitcnt lgkmcnt(9)
    v_mfma_f32_32x32x16_bf16 v[72:87], v[40:43], v[32:35], v[72:87]
    ds_read_b64_tr_b16 v[148:149], v8 offset:29696
    ds_read_b64_tr_b16 v[150:151], v8 offset:29952
    s_waitcnt lgkmcnt(9)
    v_mfma_f32_32x32x16_bf16 v[88:103], v[44:47], v[32:35], v[88:103]
    ds_read_b64_tr_b16 v[152:153], v11 offset:21504
    ds_read_b64_tr_b16 v[154:155], v12 offset:21504
    s_waitcnt lgkmcnt(9)
    v_mfma_f32_32x32x16_bf16 v[104:119], v[48:51], v[32:35], v[104:119]
    ds_read_b64_tr_b16 v[156:157], v9 offset:28672
    ds_read_b64_tr_b16 v[158:159], v9 offset:28928
    s_waitcnt lgkmcnt(9)
    v_mfma_f32_32x32x16_bf16 v[120:135], v[52:55], v[32:35], v[120:135]
    ds_read_b64_tr_b16 v[160:161], v10 offset:28672
    ds_read_b64_tr_b16 v[162:163], v10 offset:28928
    s_waitcnt lgkmcnt(8)
    v_mfma_f32_32x32x16_bf16 v[56:71], v[144:147], v[28:31], v[56:71]
    ds_read_b128 v[32:35], v7 offset:4096
    ds_read_b64_tr_b16 v[36:37], v8 offset:32768
    ds_read_b64_tr_b16 v[38:39], v8 offset:33024
    s_waitcnt lgkmcnt(9)
    v_mfma_f32_32x32x16_bf16 v[72:87], v[148:151], v[28:31], v[72:87]
    ds_read_b64_tr_b16 v[40:41], v8 offset:33792
    ds_read_b64_tr_b16 v[42:43], v8 offset:34048
    s_waitcnt lgkmcnt(9)
    v_mfma_f32_32x32x16_bf16 v[88:103], v[152:155], v[28:31], v[88:103]
    ds_read_b64_tr_b16 v[44:45], v11 offset:22016
    ds_read_b64_tr_b16 v[46:47], v12 offset:22016
    s_waitcnt lgkmcnt(9)
    v_mfma_f32_32x32x16_bf16 v[104:119], v[156:159], v[28:31], v[104:119]
    ds_read_b64_tr_b16 v[48:49], v9 offset:32768
    ds_read_b64_tr_b16 v[50:51], v9 offset:33024
    s_waitcnt lgkmcnt(9)
    v_mfma_f32_32x32x16_bf16 v[120:135], v[160:163], v[28:31], v[120:135]
    ds_read_b64_tr_b16 v[52:53], v10 offset:32768
    ds_read_b64_tr_b16 v[54:55], v10 offset:33024
    s_waitcnt lgkmcnt(0)
    s_barrier
    v_mfma_f32_32x32x16_bf16 v[56:71], v[36:39], v[32:35], v[56:71]
    ds_read_b128 v[28:31], v4 offset:8192
    ds_read_b64_tr_b16 v[144:145], v8 offset:40960
    ds_read_b64_tr_b16 v[146:147], v8 offset:41216
    v_mfma_f32_32x32x16_bf16 v[72:87], v[40:43], v[32:35], v[72:87]
    ds_read_b64_tr_b16 v[148:149], v8 offset:41984
    ds_read_b64_tr_b16 v[150:151], v8 offset:42240
    v_mfma_f32_32x32x16_bf16 v[88:103], v[44:47], v[32:35], v[88:103]
    ds_read_b64_tr_b16 v[152:153], v11 offset:40960
    ds_read_b64_tr_b16 v[154:155], v12 offset:40960
    v_mfma_f32_32x32x16_bf16 v[104:119], v[48:51], v[32:35], v[104:119]
    ds_read_b64_tr_b16 v[156:157], v9 offset:40960
    ds_read_b64_tr_b16 v[158:159], v9 offset:41216
    v_mfma_f32_32x32x16_bf16 v[120:135], v[52:55], v[32:35], v[120:135]
    ds_read_b64_tr_b16 v[160:161], v10 offset:40960
    ds_read_b64_tr_b16 v[162:163], v10 offset:41216
    s_waitcnt lgkmcnt(8)
    v_mfma_f32_32x32x16_bf16 v[56:71], v[144:147], v[28:31], v[56:71]
    ds_read_b128 v[32:35], v5 offset:8192
    ds_read_b64_tr_b16 v[36:37], v8 offset:45056
    ds_read_b64_tr_b16 v[38:39], v8 offset:45312
    s_waitcnt lgkmcnt(9)
    v_mfma_f32_32x32x16_bf16 v[72:87], v[148:151], v[28:31], v[72:87]
    ds_read_b64_tr_b16 v[40:41], v8 offset:46080
    ds_read_b64_tr_b16 v[42:43], v8 offset:46336
    s_waitcnt lgkmcnt(9)
    v_mfma_f32_32x32x16_bf16 v[88:103], v[152:155], v[28:31], v[88:103]
    ds_read_b64_tr_b16 v[44:45], v11 offset:41472
    ds_read_b64_tr_b16 v[46:47], v12 offset:41472
    s_waitcnt lgkmcnt(9)
    v_mfma_f32_32x32x16_bf16 v[104:119], v[156:159], v[28:31], v[104:119]
    ds_read_b64_tr_b16 v[48:49], v9 offset:45056
    ds_read_b64_tr_b16 v[50:51], v9 offset:45312
    s_waitcnt lgkmcnt(9)
    v_mfma_f32_32x32x16_bf16 v[120:135], v[160:163], v[28:31], v[120:135]
    ds_read_b64_tr_b16 v[52:53], v10 offset:45056
    ds_read_b64_tr_b16 v[54:55], v10 offset:45312
    s_waitcnt lgkmcnt(8)
    v_mfma_f32_32x32x16_bf16 v[56:71], v[36:39], v[32:35], v[56:71]
    ds_read_b128 v[28:31], v6 offset:8192
    ds_read_b64_tr_b16 v[144:145], v8 offset:49152
    ds_read_b64_tr_b16 v[146:147], v8 offset:49408
    s_waitcnt lgkmcnt(9)
    v_mfma_f32_32x32x16_bf16 v[72:87], v[40:43], v[32:35], v[72:87]
    ds_read_b64_tr_b16 v[148:149], v8 offset:50176
    ds_read_b64_tr_b16 v[150:151], v8 offset:50432
    s_waitcnt lgkmcnt(9)
    v_mfma_f32_32x32x16_bf16 v[88:103], v[44:47], v[32:35], v[88:103]
    ds_read_b64_tr_b16 v[152:153], v11 offset:41984
    ds_read_b64_tr_b16 v[154:155], v12 offset:41984
    s_waitcnt lgkmcnt(9)
    v_mfma_f32_32x32x16_bf16 v[104:119], v[48:51], v[32:35], v[104:119]
    ds_read_b64_tr_b16 v[156:157], v9 offset:49152
    ds_read_b64_tr_b16 v[158:159], v9 offset:49408
    s_waitcnt lgkmcnt(9)
    v_mfma_f32_32x32x16_bf16 v[120:135], v[52:55], v[32:35], v[120:135]
    ds_read_b64_tr_b16 v[160:161], v10 offset:49152
    ds_read_b64_tr_b16 v[162:163], v10 offset:49408
    s_waitcnt lgkmcnt(8)
    v_mfma_f32_32x32x16_bf16 v[56:71], v[144:147], v[28:31], v[56:71]
    ds_read_b128 v[32:35], v7 offset:8192
    ds_read_b64_tr_b16 v[36:37], v8 offset:53248
    ds_read_b64_tr_b16 v[38:39], v8 offset:53504
    s_waitcnt lgkmcnt(9)
    v_mfma_f32_32x32x16_bf16 v[72:87], v[148:151], v[28:31], v[72:87]
    ds_read_b64_tr_b16 v[40:41], v8 offset:54272
    ds_read_b64_tr_b16 v[42:43], v8 offset:54528
    s_waitcnt lgkmcnt(9)
    v_mfma_f32_32x32x16_bf16 v[88:103], v[152:155], v[28:31], v[88:103]
    ds_read_b64_tr_b16 v[44:45], v11 offset:42496
    ds_read_b64_tr_b16 v[46:47], v12 offset:42496
    s_waitcnt lgkmcnt(9)
    v_mfma_f32_32x32x16_bf16 v[104:119], v[156:159], v[28:31], v[104:119]
    ds_read_b64_tr_b16 v[48:49], v9 offset:53248
    ds_read_b64_tr_b16 v[50:51], v9 offset:53504
    s_waitcnt lgkmcnt(9)
    v_mfma_f32_32x32x16_bf16 v[120:135], v[160:163], v[28:31], v[120:135]
    ds_read_b64_tr_b16 v[52:53], v10 offset:53248
    ds_read_b64_tr_b16 v[54:55], v10 offset:53504
    s_waitcnt lgkmcnt(0)
    s_barrier
    v_mfma_f32_32x32x16_bf16 v[56:71], v[36:39], v[32:35], v[56:71]
    ds_read_b128 v[28:31], v4 offset:0
    ds_read_b64_tr_b16 v[144:145], v8 offset:0
    ds_read_b64_tr_b16 v[146:147], v8 offset:256
    v_mfma_f32_32x32x16_bf16 v[72:87], v[40:43], v[32:35], v[72:87]
    ds_read_b64_tr_b16 v[148:149], v8 offset:1024
    ds_read_b64_tr_b16 v[150:151], v8 offset:1280
    v_mfma_f32_32x32x16_bf16 v[88:103], v[44:47], v[32:35], v[88:103]
    ds_read_b64_tr_b16 v[152:153], v11 offset:0
    ds_read_b64_tr_b16 v[154:155], v12 offset:0
    v_mfma_f32_32x32x16_bf16 v[104:119], v[48:51], v[32:35], v[104:119]
    ds_read_b64_tr_b16 v[156:157], v9 offset:0
    ds_read_b64_tr_b16 v[158:159], v9 offset:256
    v_mfma_f32_32x32x16_bf16 v[120:135], v[52:55], v[32:35], v[120:135]
    ds_read_b64_tr_b16 v[160:161], v10 offset:0
    ds_read_b64_tr_b16 v[162:163], v10 offset:256
    s_waitcnt lgkmcnt(8)
    v_mfma_f32_32x32x16_bf16 v[56:71], v[144:147], v[28:31], v[56:71]
    ds_read_b128 v[32:35], v5 offset:0
    ds_read_b64_tr_b16 v[36:37], v8 offset:4096
    ds_read_b64_tr_b16 v[38:39], v8 offset:4352
    v_lshrrev_b32 v136, 3, v1
    v_and_b32 v137, 7, v1
    v_bfe_u32 v138, v1, 4, 1
    v_lshlrev_b32 v138, 2, v138
    v_xor_b32 v137, v137, v138
    s_waitcnt lgkmcnt(9)
    v_mfma_f32_32x32x16_bf16 v[72:87], v[148:151], v[28:31], v[72:87]
    ds_read_b64_tr_b16 v[40:41], v8 offset:5120
    ds_read_b64_tr_b16 v[42:43], v8 offset:5376
    s_lshl_b32 s74, s66, 7
    v_lshlrev_b32 v137, 4, v137
    v_add_u32 v137, s74, v137
    v_mul_u32_u24 v21, 896, v136
    v_add_u32 v21, v21, v137
    s_waitcnt lgkmcnt(9)
    v_mfma_f32_32x32x16_bf16 v[88:103], v[152:155], v[28:31], v[88:103]
    ds_read_b64_tr_b16 v[44:45], v11 offset:512
    ds_read_b64_tr_b16 v[46:47], v12 offset:512
    v_and_b32 v15, 31, v1
    v_lshlrev_b32 v15, 3, v15
    s_lshl_b32 s74, s3, 8
    s_add_u32 s74, s74, 156672
    v_add_u32 v15, s74, v15
    s_waitcnt lgkmcnt(9)
    v_mfma_f32_32x32x16_bf16 v[104:119], v[156:159], v[28:31], v[104:119]
    ds_read_b64_tr_b16 v[48:49], v9 offset:4096
    ds_read_b64_tr_b16 v[50:51], v9 offset:4352
    s_bfe_u32 s78, s3, 0x10001
    s_lshr_b32 s79, s3, 2
    v_bfe_u32 v136, v1, 2, 2
    v_lshrrev_b32 v137, 5, v1
    v_lshl_add_u32 v138, v137, 2, v136
    s_waitcnt lgkmcnt(9)
    v_mfma_f32_32x32x16_bf16 v[120:135], v[160:163], v[28:31], v[120:135]
    ds_read_b64_tr_b16 v[52:53], v10 offset:4096
    ds_read_b64_tr_b16 v[54:55], v10 offset:4352
    v_lshlrev_b32 v138, 7, v138
    v_lshrrev_b32 v136, 1, v136
    v_xor_b32 v136, s78, v136
    v_lshl_add_u32 v138, v136, 6, v138
    v_and_b32 v136, 1, v1
    s_waitcnt lgkmcnt(8)
    v_mfma_f32_32x32x16_bf16 v[56:71], v[36:39], v[32:35], v[56:71]
    ds_read_b128 v[28:31], v6 offset:0
    ds_read_b64_tr_b16 v[144:145], v8 offset:8192
    ds_read_b64_tr_b16 v[146:147], v8 offset:8448
    v_lshl_add_u32 v138, v136, 5, v138
    v_bfe_u32 v136, v1, 1, 1
    v_bfe_u32 v139, v1, 4, 1
    v_xor_b32 v139, s79, v139
    v_lshl_add_u32 v136, v139, 1, v136
    s_waitcnt lgkmcnt(9)
    v_mfma_f32_32x32x16_bf16 v[72:87], v[40:43], v[32:35], v[72:87]
    ds_read_b64_tr_b16 v[148:149], v8 offset:9216
    ds_read_b64_tr_b16 v[150:151], v8 offset:9472
    v_lshl_add_u32 v138, v136, 3, v138
    s_mul_i32 s74, s3, 18432
    v_add_u32 v22, s74, v138
    s_and_b32 s74, s3, 3
    s_lshl_b32 s74, s74, 1
    s_waitcnt lgkmcnt(9)
    v_mfma_f32_32x32x16_bf16 v[88:103], v[44:47], v[32:35], v[88:103]
    ds_read_b64_tr_b16 v[152:153], v11 offset:1024
    ds_read_b64_tr_b16 v[154:155], v12 offset:1024
    s_add_u32 s72, s74, s79
    s_mul_i32 s69, s72, 200704
    s_cmp_ge_u32 s2, 224
    s_cselect_b32 s74, 0x40000000, 0
    s_add_u32 s69, s69, s74
    s_waitcnt lgkmcnt(9)
    v_mfma_f32_32x32x16_bf16 v[104:119], v[48:51], v[32:35], v[104:119]
    ds_read_b64_tr_b16 v[156:157], v9 offset:8192
    ds_read_b64_tr_b16 v[158:159], v9 offset:8448
    s_waitcnt lgkmcnt(9)
    v_mfma_f32_32x32x16_bf16 v[120:135], v[52:55], v[32:35], v[120:135]
    ds_read_b64_tr_b16 v[160:161], v10 offset:8192
    ds_read_b64_tr_b16 v[162:163], v10 offset:8448
    s_waitcnt lgkmcnt(8)
    v_mfma_f32_32x32x16_bf16 v[56:71], v[144:147], v[28:31], v[56:71]
    ds_read_b128 v[32:35], v7 offset:0
    ds_read_b64_tr_b16 v[36:37], v8 offset:12288
    ds_read_b64_tr_b16 v[38:39], v8 offset:12544
    s_waitcnt lgkmcnt(9)
    v_mfma_f32_32x32x16_bf16 v[72:87], v[148:151], v[28:31], v[72:87]
    ds_read_b64_tr_b16 v[40:41], v8 offset:13312
    ds_read_b64_tr_b16 v[42:43], v8 offset:13568
    s_waitcnt lgkmcnt(9)
    v_mfma_f32_32x32x16_bf16 v[88:103], v[152:155], v[28:31], v[88:103]
    ds_read_b64_tr_b16 v[44:45], v11 offset:1536
    ds_read_b64_tr_b16 v[46:47], v12 offset:1536
    s_waitcnt lgkmcnt(9)
    v_mfma_f32_32x32x16_bf16 v[104:119], v[156:159], v[28:31], v[104:119]
    ds_read_b64_tr_b16 v[48:49], v9 offset:12288
    ds_read_b64_tr_b16 v[50:51], v9 offset:12544
    s_waitcnt lgkmcnt(9)
    v_mfma_f32_32x32x16_bf16 v[120:135], v[160:163], v[28:31], v[120:135]
    ds_read_b64_tr_b16 v[52:53], v10 offset:12288
    ds_read_b64_tr_b16 v[54:55], v10 offset:12544
    s_waitcnt lgkmcnt(0)
    s_barrier
    v_mfma_f32_32x32x16_bf16 v[56:71], v[36:39], v[32:35], v[56:71]
    ds_read_b128 v[28:31], v4 offset:4096
    ds_read_b64_tr_b16 v[144:145], v8 offset:20480
    ds_read_b64_tr_b16 v[146:147], v8 offset:20736
    v_mfma_f32_32x32x16_bf16 v[72:87], v[40:43], v[32:35], v[72:87]
    ds_read_b64_tr_b16 v[148:149], v8 offset:21504
    ds_read_b64_tr_b16 v[150:151], v8 offset:21760
    v_mfma_f32_32x32x16_bf16 v[88:103], v[44:47], v[32:35], v[88:103]
    ds_read_b64_tr_b16 v[152:153], v11 offset:20480
    ds_read_b64_tr_b16 v[154:155], v12 offset:20480
    v_mfma_f32_32x32x16_bf16 v[104:119], v[48:51], v[32:35], v[104:119]
    ds_read_b64_tr_b16 v[156:157], v9 offset:20480
    ds_read_b64_tr_b16 v[158:159], v9 offset:20736
    v_mfma_f32_32x32x16_bf16 v[120:135], v[52:55], v[32:35], v[120:135]
    ds_read_b64_tr_b16 v[160:161], v10 offset:20480
    ds_read_b64_tr_b16 v[162:163], v10 offset:20736
    s_waitcnt lgkmcnt(8)
    v_mfma_f32_32x32x16_bf16 v[56:71], v[144:147], v[28:31], v[56:71]
    ds_read_b128 v[32:35], v5 offset:4096
    ds_read_b64_tr_b16 v[36:37], v8 offset:24576
    ds_read_b64_tr_b16 v[38:39], v8 offset:24832
    s_waitcnt lgkmcnt(9)
    v_mfma_f32_32x32x16_bf16 v[72:87], v[148:151], v[28:31], v[72:87]
    ds_read_b64_tr_b16 v[40:41], v8 offset:25600
    ds_read_b64_tr_b16 v[42:43], v8 offset:25856
    s_waitcnt lgkmcnt(9)
    v_mfma_f32_32x32x16_bf16 v[88:103], v[152:155], v[28:31], v[88:103]
    ds_read_b64_tr_b16 v[44:45], v11 offset:20992
    ds_read_b64_tr_b16 v[46:47], v12 offset:20992
    s_waitcnt lgkmcnt(9)
    v_mfma_f32_32x32x16_bf16 v[104:119], v[156:159], v[28:31], v[104:119]
    ds_read_b64_tr_b16 v[48:49], v9 offset:24576
    ds_read_b64_tr_b16 v[50:51], v9 offset:24832
    s_waitcnt lgkmcnt(9)
    v_mfma_f32_32x32x16_bf16 v[120:135], v[160:163], v[28:31], v[120:135]
    ds_read_b64_tr_b16 v[52:53], v10 offset:24576
    ds_read_b64_tr_b16 v[54:55], v10 offset:24832
    s_waitcnt lgkmcnt(8)
    v_mfma_f32_32x32x16_bf16 v[56:71], v[36:39], v[32:35], v[56:71]
    ds_read_b128 v[28:31], v6 offset:4096
    ds_read_b64_tr_b16 v[144:145], v8 offset:28672
    ds_read_b64_tr_b16 v[146:147], v8 offset:28928
    s_waitcnt lgkmcnt(9)
    v_mfma_f32_32x32x16_bf16 v[72:87], v[40:43], v[32:35], v[72:87]
    ds_read_b64_tr_b16 v[148:149], v8 offset:29696
    ds_read_b64_tr_b16 v[150:151], v8 offset:29952
    s_waitcnt lgkmcnt(9)
    v_mfma_f32_32x32x16_bf16 v[88:103], v[44:47], v[32:35], v[88:103]
    ds_read_b64_tr_b16 v[152:153], v11 offset:21504
    ds_read_b64_tr_b16 v[154:155], v12 offset:21504
    s_waitcnt lgkmcnt(9)
    v_mfma_f32_32x32x16_bf16 v[104:119], v[48:51], v[32:35], v[104:119]
    ds_read_b64_tr_b16 v[156:157], v9 offset:28672
    ds_read_b64_tr_b16 v[158:159], v9 offset:28928
    s_waitcnt lgkmcnt(9)
    v_mfma_f32_32x32x16_bf16 v[120:135], v[52:55], v[32:35], v[120:135]
    ds_read_b64_tr_b16 v[160:161], v10 offset:28672
    ds_read_b64_tr_b16 v[162:163], v10 offset:28928
    s_waitcnt lgkmcnt(8)
    v_mfma_f32_32x32x16_bf16 v[56:71], v[144:147], v[28:31], v[56:71]
    ds_read_b128 v[32:35], v7 offset:4096
    ds_read_b64_tr_b16 v[36:37], v8 offset:32768
    ds_read_b64_tr_b16 v[38:39], v8 offset:33024
    s_waitcnt lgkmcnt(9)
    v_mfma_f32_32x32x16_bf16 v[72:87], v[148:151], v[28:31], v[72:87]
    ds_read_b64_tr_b16 v[40:41], v8 offset:33792
    ds_read_b64_tr_b16 v[42:43], v8 offset:34048
    s_waitcnt lgkmcnt(9)
    v_mfma_f32_32x32x16_bf16 v[88:103], v[152:155], v[28:31], v[88:103]
    ds_read_b64_tr_b16 v[44:45], v11 offset:22016
    ds_read_b64_tr_b16 v[46:47], v12 offset:22016
    s_waitcnt lgkmcnt(9)
    v_mfma_f32_32x32x16_bf16 v[104:119], v[156:159], v[28:31], v[104:119]
    ds_read_b64_tr_b16 v[48:49], v9 offset:32768
    ds_read_b64_tr_b16 v[50:51], v9 offset:33024
    s_waitcnt lgkmcnt(9)
    v_mfma_f32_32x32x16_bf16 v[120:135], v[160:163], v[28:31], v[120:135]
    ds_read_b64_tr_b16 v[52:53], v10 offset:32768
    ds_read_b64_tr_b16 v[54:55], v10 offset:33024
    s_waitcnt lgkmcnt(0)
    s_barrier
    v_mfma_f32_32x32x16_bf16 v[56:71], v[36:39], v[32:35], v[56:71]
    ds_read_b128 v[28:31], v4 offset:8192
    ds_read_b64_tr_b16 v[144:145], v8 offset:40960
    ds_read_b64_tr_b16 v[146:147], v8 offset:41216
    v_mfma_f32_32x32x16_bf16 v[72:87], v[40:43], v[32:35], v[72:87]
    ds_read_b64_tr_b16 v[148:149], v8 offset:41984
    ds_read_b64_tr_b16 v[150:151], v8 offset:42240
    v_mfma_f32_32x32x16_bf16 v[88:103], v[44:47], v[32:35], v[88:103]
    ds_read_b64_tr_b16 v[152:153], v11 offset:40960
    ds_read_b64_tr_b16 v[154:155], v12 offset:40960
    v_mfma_f32_32x32x16_bf16 v[104:119], v[48:51], v[32:35], v[104:119]
    ds_read_b64_tr_b16 v[156:157], v9 offset:40960
    ds_read_b64_tr_b16 v[158:159], v9 offset:41216
    v_mfma_f32_32x32x16_bf16 v[120:135], v[52:55], v[32:35], v[120:135]
    ds_read_b64_tr_b16 v[160:161], v10 offset:40960
    ds_read_b64_tr_b16 v[162:163], v10 offset:41216
    s_waitcnt lgkmcnt(8)
    v_mfma_f32_32x32x16_bf16 v[56:71], v[144:147], v[28:31], v[56:71]
    ds_read_b128 v[32:35], v5 offset:8192
    ds_read_b64_tr_b16 v[36:37], v8 offset:45056
    ds_read_b64_tr_b16 v[38:39], v8 offset:45312
    s_waitcnt lgkmcnt(9)
    v_mfma_f32_32x32x16_bf16 v[72:87], v[148:151], v[28:31], v[72:87]
    ds_read_b64_tr_b16 v[40:41], v8 offset:46080
    ds_read_b64_tr_b16 v[42:43], v8 offset:46336
    s_waitcnt lgkmcnt(9)
    v_mfma_f32_32x32x16_bf16 v[88:103], v[152:155], v[28:31], v[88:103]
    ds_read_b64_tr_b16 v[44:45], v11 offset:41472
    ds_read_b64_tr_b16 v[46:47], v12 offset:41472
    s_waitcnt lgkmcnt(9)
    v_mfma_f32_32x32x16_bf16 v[104:119], v[156:159], v[28:31], v[104:119]
    ds_read_b64_tr_b16 v[48:49], v9 offset:45056
    ds_read_b64_tr_b16 v[50:51], v9 offset:45312
    s_waitcnt lgkmcnt(9)
    v_mfma_f32_32x32x16_bf16 v[120:135], v[160:163], v[28:31], v[120:135]
    ds_read_b64_tr_b16 v[52:53], v10 offset:45056
    ds_read_b64_tr_b16 v[54:55], v10 offset:45312
    s_waitcnt lgkmcnt(8)
    v_mfma_f32_32x32x16_bf16 v[56:71], v[36:39], v[32:35], v[56:71]
    ds_read_b128 v[28:31], v6 offset:8192
    ds_read_b64_tr_b16 v[144:145], v8 offset:49152
    ds_read_b64_tr_b16 v[146:147], v8 offset:49408
    s_waitcnt lgkmcnt(9)
    v_mfma_f32_32x32x16_bf16 v[72:87], v[40:43], v[32:35], v[72:87]
    ds_read_b64_tr_b16 v[148:149], v8 offset:50176
    ds_read_b64_tr_b16 v[150:151], v8 offset:50432
    s_waitcnt lgkmcnt(9)
    v_mfma_f32_32x32x16_bf16 v[88:103], v[44:47], v[32:35], v[88:103]
    ds_read_b64_tr_b16 v[152:153], v11 offset:41984
    ds_read_b64_tr_b16 v[154:155], v12 offset:41984
    s_waitcnt lgkmcnt(9)
    v_mfma_f32_32x32x16_bf16 v[104:119], v[48:51], v[32:35], v[104:119]
    ds_read_b64_tr_b16 v[156:157], v9 offset:49152
    ds_read_b64_tr_b16 v[158:159], v9 offset:49408
    s_waitcnt lgkmcnt(9)
    v_mfma_f32_32x32x16_bf16 v[120:135], v[52:55], v[32:35], v[120:135]
    ds_read_b64_tr_b16 v[160:161], v10 offset:49152
    ds_read_b64_tr_b16 v[162:163], v10 offset:49408
    s_waitcnt lgkmcnt(8)
    v_mfma_f32_32x32x16_bf16 v[56:71], v[144:147], v[28:31], v[56:71]
    ds_read_b128 v[32:35], v7 offset:8192
    ds_read_b64_tr_b16 v[36:37], v8 offset:53248
    ds_read_b64_tr_b16 v[38:39], v8 offset:53504
    s_waitcnt lgkmcnt(9)
    v_mfma_f32_32x32x16_bf16 v[72:87], v[148:151], v[28:31], v[72:87]
    ds_read_b64_tr_b16 v[40:41], v8 offset:54272
    ds_read_b64_tr_b16 v[42:43], v8 offset:54528
    s_waitcnt lgkmcnt(9)
    v_mfma_f32_32x32x16_bf16 v[88:103], v[152:155], v[28:31], v[88:103]
    ds_read_b64_tr_b16 v[44:45], v11 offset:42496
    ds_read_b64_tr_b16 v[46:47], v12 offset:42496
    s_waitcnt lgkmcnt(9)
    v_mfma_f32_32x32x16_bf16 v[104:119], v[156:159], v[28:31], v[104:119]
    ds_read_b64_tr_b16 v[48:49], v9 offset:53248
    ds_read_b64_tr_b16 v[50:51], v9 offset:53504
    s_waitcnt lgkmcnt(9)
    v_mfma_f32_32x32x16_bf16 v[120:135], v[160:163], v[28:31], v[120:135]
    ds_read_b64_tr_b16 v[52:53], v10 offset:53248
    ds_read_b64_tr_b16 v[54:55], v10 offset:53504
    s_waitcnt lgkmcnt(0)
    s_barrier
    v_mfma_f32_32x32x16_bf16 v[56:71], v[36:39], v[32:35], v[56:71]
    ds_read_b128 v[28:31], v4 offset:0
    ds_read_b64_tr_b16 v[144:145], v8 offset:0
    ds_read_b64_tr_b16 v[146:147], v8 offset:256
    v_mfma_f32_32x32x16_bf16 v[72:87], v[40:43], v[32:35], v[72:87]
    ds_read_b64_tr_b16 v[148:149], v8 offset:1024
    ds_read_b64_tr_b16 v[150:151], v8 offset:1280
    v_mfma_f32_32x32x16_bf16 v[88:103], v[44:47], v[32:35], v[88:103]
    ds_read_b64_tr_b16 v[152:153], v11 offset:0
    ds_read_b64_tr_b16 v[154:155], v12 offset:0
    v_mfma_f32_32x32x16_bf16 v[104:119], v[48:51], v[32:35], v[104:119]
    ds_read_b64_tr_b16 v[156:157], v9 offset:0
    ds_read_b64_tr_b16 v[158:159], v9 offset:256
    v_mfma_f32_32x32x16_bf16 v[120:135], v[52:55], v[32:35], v[120:135]
    ds_read_b64_tr_b16 v[160:161], v10 offset:0
    ds_read_b64_tr_b16 v[162:163], v10 offset:256
    s_waitcnt lgkmcnt(8)
    v_mfma_f32_32x32x16_bf16 v[56:71], v[144:147], v[28:31], v[56:71]
    ds_read_b128 v[32:35], v5 offset:0
    ds_read_b64_tr_b16 v[36:37], v8 offset:4096
    ds_read_b64_tr_b16 v[38:39], v8 offset:4352
    s_waitcnt lgkmcnt(9)
    v_mfma_f32_32x32x16_bf16 v[72:87], v[148:151], v[28:31], v[72:87]
    ds_read_b64_tr_b16 v[40:41], v8 offset:5120
    ds_read_b64_tr_b16 v[42:43], v8 offset:5376
    s_waitcnt lgkmcnt(9)
    v_mfma_f32_32x32x16_bf16 v[88:103], v[152:155], v[28:31], v[88:103]
    ds_read_b64_tr_b16 v[44:45], v11 offset:512
    ds_read_b64_tr_b16 v[46:47], v12 offset:512
    s_waitcnt lgkmcnt(9)
    v_mfma_f32_32x32x16_bf16 v[104:119], v[156:159], v[28:31], v[104:119]
    ds_read_b64_tr_b16 v[48:49], v9 offset:4096
    ds_read_b64_tr_b16 v[50:51], v9 offset:4352
    s_waitcnt lgkmcnt(9)
    v_mfma_f32_32x32x16_bf16 v[120:135], v[160:163], v[28:31], v[120:135]
    ds_read_b64_tr_b16 v[52:53], v10 offset:4096
    ds_read_b64_tr_b16 v[54:55], v10 offset:4352
    s_waitcnt lgkmcnt(8)
    v_mfma_f32_32x32x16_bf16 v[56:71], v[36:39], v[32:35], v[56:71]
    ds_read_b128 v[28:31], v6 offset:0
    ds_read_b64_tr_b16 v[144:145], v8 offset:8192
    ds_read_b64_tr_b16 v[146:147], v8 offset:8448
    s_waitcnt lgkmcnt(9)
    v_mfma_f32_32x32x16_bf16 v[72:87], v[40:43], v[32:35], v[72:87]
    ds_read_b64_tr_b16 v[148:149], v8 offset:9216
    ds_read_b64_tr_b16 v[150:151], v8 offset:9472
    s_waitcnt lgkmcnt(9)
    v_mfma_f32_32x32x16_bf16 v[88:103], v[44:47], v[32:35], v[88:103]
    ds_read_b64_tr_b16 v[152:153], v11 offset:1024
    ds_read_b64_tr_b16 v[154:155], v12 offset:1024
    s_waitcnt lgkmcnt(9)
    v_mfma_f32_32x32x16_bf16 v[104:119], v[48:51], v[32:35], v[104:119]
    ds_read_b64_tr_b16 v[156:157], v9 offset:8192
    ds_read_b64_tr_b16 v[158:159], v9 offset:8448
    s_waitcnt lgkmcnt(9)
    v_mfma_f32_32x32x16_bf16 v[120:135], v[52:55], v[32:35], v[120:135]
    ds_read_b64_tr_b16 v[160:161], v10 offset:8192
    ds_read_b64_tr_b16 v[162:163], v10 offset:8448
    s_waitcnt lgkmcnt(8)
    v_mfma_f32_32x32x16_bf16 v[56:71], v[144:147], v[28:31], v[56:71]
    ds_read_b128 v[32:35], v7 offset:0
    ds_read_b64_tr_b16 v[36:37], v8 offset:12288
    ds_read_b64_tr_b16 v[38:39], v8 offset:12544
    s_waitcnt lgkmcnt(9)
    v_mfma_f32_32x32x16_bf16 v[72:87], v[148:151], v[28:31], v[72:87]
    ds_read_b64_tr_b16 v[40:41], v8 offset:13312
    ds_read_b64_tr_b16 v[42:43], v8 offset:13568
    s_waitcnt lgkmcnt(9)
    v_mfma_f32_32x32x16_bf16 v[88:103], v[152:155], v[28:31], v[88:103]
    ds_read_b64_tr_b16 v[44:45], v11 offset:1536
    ds_read_b64_tr_b16 v[46:47], v12 offset:1536
    s_waitcnt lgkmcnt(9)
    v_mfma_f32_32x32x16_bf16 v[104:119], v[156:159], v[28:31], v[104:119]
    ds_read_b64_tr_b16 v[48:49], v9 offset:12288
    ds_read_b64_tr_b16 v[50:51], v9 offset:12544
    s_waitcnt lgkmcnt(9)
    v_mfma_f32_32x32x16_bf16 v[120:135], v[160:163], v[28:31], v[120:135]
    ds_read_b64_tr_b16 v[52:53], v10 offset:12288
    ds_read_b64_tr_b16 v[54:55], v10 offset:12544
    s_waitcnt lgkmcnt(0)
    s_barrier
    ds_read_b64 v[16:17], v15
    ds_read_b128 v[144:147], v13 offset:0
    ds_read_b128 v[148:151], v13 offset:1024
    ds_read_b128 v[152:155], v13 offset:2048
    ds_read_b128 v[156:159], v13 offset:3072
    ds_read_b128 v[160:163], v13 offset:4096
    s_waitcnt lgkmcnt(5)
    v_mov_b32 v24, v16
    v_mov_b32 v25, v16
    v_mov_b32 v26, v16
    v_mov_b32 v27, v16
    v_rcp_f32 v16, v17
    v_mul_f32 v20, v17, v17
    v_mul_f32 v18, 0xc0135761, v16
    v_mul_f32 v19, v16, v16
    v_mul_f32 v19, v19, v18
    v_mul_f32 v19, 0x3d372713, v19
    v_mfma_f32_32x32x16_bf16 v[56:71], v[36:39], v[32:35], v[56:71]
    v_mfma_f32_32x32x16_bf16 v[72:87], v[40:43], v[32:35], v[72:87]
    v_mfma_f32_32x32x16_bf16 v[88:103], v[44:47], v[32:35], v[88:103]
    v_mfma_f32_32x32x16_bf16 v[104:119], v[48:51], v[32:35], v[104:119]
    v_mfma_f32_32x32x16_bf16 v[120:135], v[52:55], v[32:35], v[120:135]
    s_waitcnt lgkmcnt(4)
    v_mfma_f32_32x32x16_bf16 v[56:71], v[144:147], v[24:27], v[56:71]
    ds_read_b64_tr_b16 v[28:29], v14 offset:0
    ds_read_b64_tr_b16 v[30:31], v14 offset:512
    ds_read_b64_tr_b16 v[32:33], v14 offset:1024
    ds_read_b64_tr_b16 v[34:35], v14 offset:1536
    s_waitcnt lgkmcnt(7)
    v_mfma_f32_32x32x16_bf16 v[72:87], v[148:151], v[24:27], v[72:87]
    s_mul_i32 s70, s3, 18432
    v_mov_b32 v11, v21
    v_mov_b32 v12, v22
    v_xor_b32 v13, 64, v22
    v_and_b32 v4, 31, v1
    v_lshrrev_b32 v5, 5, v1
    v_lshlrev_b32 v5, 1, v5
    v_bfe_u32 v6, v1, 1, 2
    v_xor_b32 v6, v6, v5
    v_lshlrev_b32 v7, 6, v4
    v_lshl_add_u32 v7, v6, 4, v7
    s_add_u32 s74, s70, 16384
    v_add_u32 v9, s74, v7
    v_xor_b32 v10, 16, v9
    v_and_b32 v7, 7, v1
    v_xor_b32 v5, v5, v7
    v_lshlrev_b32 v4, 7, v4
    v_lshl_add_u32 v4, v5, 4, v4
    s_add_u32 s74, s70, 12288
    v_add_u32 v164, s74, v4
    v_xor_b32 v165, 16, v164
    v_xor_b32 v166, 64, v164
    v_xor_b32 v167, 0x50, v164
    s_and_b32 s74, s2, 7
    s_lshl_b32 s74, s74, 2
    s_add_u32 s74, s74, 162048
    v_mov_b32 v15, s74
    ds_read_b32 v15, v15
    s_waitcnt lgkmcnt(0)
    v_readfirstlane_b32 s98, v15
    v_pk_mul_f32 v[56:57], v[56:57], v[16:17] op_sel_hi:[1,0]
    v_pk_mul_f32 v[58:59], v[58:59], v[16:17] op_sel_hi:[1,0]
    v_pk_mul_f32 v[60:61], v[60:61], v[16:17] op_sel_hi:[1,0]
    v_pk_mul_f32 v[62:63], v[62:63], v[16:17] op_sel_hi:[1,0]
    v_pk_mul_f32 v[64:65], v[64:65], v[16:17] op_sel_hi:[1,0]
    v_pk_mul_f32 v[66:67], v[66:67], v[16:17] op_sel_hi:[1,0]
    v_pk_mul_f32 v[68:69], v[68:69], v[16:17] op_sel_hi:[1,0]
    v_pk_mul_f32 v[70:71], v[70:71], v[16:17] op_sel_hi:[1,0]
    v_cvt_pk_bf16_f32 v44, v56, v57
    v_cvt_pk_bf16_f32 v45, v58, v59
    v_cvt_pk_bf16_f32 v46, v60, v61
    v_cvt_pk_bf16_f32 v47, v62, v63
    v_cvt_pk_bf16_f32 v48, v64, v65
    v_cvt_pk_bf16_f32 v49, v66, v67
    v_cvt_pk_bf16_f32 v50, v68, v69
    v_cvt_pk_bf16_f32 v51, v70, v71
    v_mfma_f32_32x32x16_bf16 v[56:71], v[28:31], v[44:47], 0
    s_nop 0
    v_mfma_f32_32x32x16_bf16 v[56:71], v[32:35], v[48:51], v[56:71]
    v_pk_mul_f32 v[72:73], v[72:73], v[16:17] op_sel_hi:[1,0]
    v_pk_mul_f32 v[74:75], v[74:75], v[16:17] op_sel_hi:[1,0]
    v_pk_mul_f32 v[76:77], v[76:77], v[16:17] op_sel_hi:[1,0]
    v_pk_mul_f32 v[78:79], v[78:79], v[16:17] op_sel_hi:[1,0]
    v_pk_mul_f32 v[80:81], v[80:81], v[16:17] op_sel_hi:[1,0]
    v_pk_mul_f32 v[82:83], v[82:83], v[16:17] op_sel_hi:[1,0]
    v_pk_mul_f32 v[84:85], v[84:85], v[16:17] op_sel_hi:[1,0]
    v_pk_mul_f32 v[86:87], v[86:87], v[16:17] op_sel_hi:[1,0]
    v_cvt_pk_bf16_f32 v72, v72, v73
    v_cvt_pk_bf16_f32 v73, v74, v75
    v_cvt_pk_bf16_f32 v74, v76, v77
    v_cvt_pk_bf16_f32 v75, v78, v79
    v_cvt_pk_bf16_f32 v76, v80, v81
    v_cvt_pk_bf16_f32 v77, v82, v83
    v_cvt_pk_bf16_f32 v78, v84, v85
    v_cvt_pk_bf16_f32 v79, v86, v87
    v_mov_b32 v80, 0x3f803f80
    v_cndmask_b32_e64 v78, v78, v80, s[80:81]
    v_cvt_pk_bf16_f32 v36, v56, v57
    v_cvt_pk_bf16_f32 v37, v58, v59
    v_cvt_pk_bf16_f32 v38, v60, v61
    v_cvt_pk_bf16_f32 v39, v62, v63
    v_cvt_pk_bf16_f32 v40, v64, v65
    v_cvt_pk_bf16_f32 v41, v66, v67
    v_cvt_pk_bf16_f32 v42, v68, v69
    v_lshlrev_b32 v56, 16, v36
    v_and_b32 v57, 0xffff0000, v36
    v_lshlrev_b32 v58, 16, v37
    v_and_b32 v59, 0xffff0000, v37
    v_lshlrev_b32 v60, 16, v38
    v_and_b32 v61, 0xffff0000, v38
    v_lshlrev_b32 v62, 16, v39
    v_and_b32 v63, 0xffff0000, v39
    v_lshlrev_b32 v64, 16, v40
    v_and_b32 v65, 0xffff0000, v40
    v_lshlrev_b32 v66, 16, v41
    v_and_b32 v67, 0xffff0000, v41
    v_lshlrev_b32 v68, 16, v42
    v_and_b32 v69, 0xffff0000, v42
    v_mov_b32 v8, 0x3fb8aa3b
    v_max3_f32 v4, v56, v57, v58
    v_min3_f32 v5, v56, v57, v58
    v_max3_f32 v4, v4, v59, v60
    v_min3_f32 v5, v5, v59, v60
    v_max3_f32 v4, v4, v61, v62
    v_min3_f32 v5, v5, v61, v62
    v_max3_f32 v4, v4, v63, v64
    v_min3_f32 v5, v5, v63, v64
    v_max3_f32 v4, v4, v65, v66
    v_min3_f32 v5, v5, v65, v66
    v_max3_f32 v4, v4, v67, v68
    v_min3_f32 v5, v5, v67, v68
    v_max_f32 v4, v4, v69
    v_min_f32 v5, v5, v69
    v_mov_b32 v6, v4
    v_mov_b32 v7, v5
    s_nop 0
    v_permlane32_swap_b32 v6, v4
    v_permlane32_swap_b32 v7, v5
    v_max_f32 v4, v4, v6
    v_min_f32 v5, v5, v7
    v_pk_mul_f32 v[4:5], v[4:5], v[8:9] op_sel_hi:[1,0]
    v_pk_fma_f32 v[36:37], v[56:57], v[8:9], v[4:5] op_sel_hi:[1,0,0] neg_lo:[0,0,1] neg_hi:[0,0,1]
    v_pk_fma_f32 v[38:39], v[58:59], v[8:9], v[4:5] op_sel_hi:[1,0,0] neg_lo:[0,0,1] neg_hi:[0,0,1]
    v_pk_fma_f32 v[40:41], v[60:61], v[8:9], v[4:5] op_sel_hi:[1,0,0] neg_lo:[0,0,1] neg_hi:[0,0,1]
    v_pk_fma_f32 v[42:43], v[62:63], v[8:9], v[4:5] op_sel_hi:[1,0,0] neg_lo:[0,0,1] neg_hi:[0,0,1]
    v_pk_fma_f32 v[44:45], v[64:65], v[8:9], v[4:5] op_sel_hi:[1,0,0] neg_lo:[0,0,1] neg_hi:[0,0,1]
    v_pk_fma_f32 v[46:47], v[66:67], v[8:9], v[4:5] op_sel_hi:[1,0,0] neg_lo:[0,0,1] neg_hi:[0,0,1]
    v_pk_fma_f32 v[48:49], v[68:69], v[8:9], v[4:5] op_sel_hi:[1,0,0] neg_lo:[0,0,1] neg_hi:[0,0,1]
    v_pk_fma_f32 v[56:57], v[56:57], v[8:9], v[4:5] op_sel:[0,0,1] op_sel_hi:[1,0,1] neg_lo:[1,0,0] neg_hi:[1,0,0]
    v_pk_fma_f32 v[58:59], v[58:59], v[8:9], v[4:5] op_sel:[0,0,1] op_sel_hi:[1,0,1] neg_lo:[1,0,0] neg_hi:[1,0,0]
    v_pk_fma_f32 v[60:61], v[60:61], v[8:9], v[4:5] op_sel:[0,0,1] op_sel_hi:[1,0,1] neg_lo:[1,0,0] neg_hi:[1,0,0]
    v_pk_fma_f32 v[62:63], v[62:63], v[8:9], v[4:5] op_sel:[0,0,1] op_sel_hi:[1,0,1] neg_lo:[1,0,0] neg_hi:[1,0,0]
    v_pk_fma_f32 v[64:65], v[64:65], v[8:9], v[4:5] op_sel:[0,0,1] op_sel_hi:[1,0,1] neg_lo:[1,0,0] neg_hi:[1,0,0]
    v_pk_fma_f32 v[66:67], v[66:67], v[8:9], v[4:5] op_sel:[0,0,1] op_sel_hi:[1,0,1] neg_lo:[1,0,0] neg_hi:[1,0,0]
    v_pk_fma_f32 v[68:69], v[68:69], v[8:9], v[4:5] op_sel:[0,0,1] op_sel_hi:[1,0,1] neg_lo:[1,0,0] neg_hi:[1,0,0]
    v_exp_f32 v36, v36
    v_exp_f32 v37, v37
    v_exp_f32 v38, v38
    v_exp_f32 v39, v39
    v_exp_f32 v40, v40
    v_exp_f32 v41, v41
    v_exp_f32 v42, v42
    v_exp_f32 v43, v43
    v_exp_f32 v44, v44
    v_exp_f32 v45, v45
    v_exp_f32 v46, v46
    v_exp_f32 v47, v47
    v_exp_f32 v48, v48
    v_exp_f32 v49, v49
    v_exp_f32 v56, v56
    v_exp_f32 v57, v57
    v_exp_f32 v58, v58
    v_exp_f32 v59, v59
    v_exp_f32 v60, v60
    v_exp_f32 v61, v61
    v_exp_f32 v62, v62
    v_exp_f32 v63, v63
    v_exp_f32 v64, v64
    v_exp_f32 v65, v65
    v_exp_f32 v66, v66
    v_exp_f32 v67, v67
    v_exp_f32 v68, v68
    v_exp_f32 v69, v69
    v_pk_add_f32 v[4:5], v[36:37], v[38:39]
    v_pk_add_f32 v[6:7], v[56:57], v[58:59]
    v_pk_add_f32 v[4:5], v[4:5], v[40:41]
    v_pk_add_f32 v[6:7], v[6:7], v[60:61]
    v_pk_add_f32 v[4:5], v[4:5], v[42:43]
    v_pk_add_f32 v[6:7], v[6:7], v[62:63]
    v_pk_add_f32 v[4:5], v[4:5], v[44:45]
    v_pk_add_f32 v[6:7], v[6:7], v[64:65]
    v_pk_add_f32 v[4:5], v[4:5], v[46:47]
    v_pk_add_f32 v[6:7], v[6:7], v[66:67]
    v_pk_add_f32 v[4:5], v[4:5], v[48:49]
    v_pk_add_f32 v[6:7], v[6:7], v[68:69]
    v_add_f32 v4, v4, v5
    v_add_f32 v5, v6, v7
    v_mov_b32 v6, v4
    v_mov_b32 v7, v5
    s_nop 0
    v_permlane32_swap_b32 v6, v4
    v_permlane32_swap_b32 v7, v5
    v_pk_add_f32 v[4:5], v[4:5], v[6:7]
    v_rcp_f32 v4, v4
    v_rcp_f32 v5, v5
    s_nop 0
    v_pk_mul_f32 v[36:37], v[36:37], v[4:5] op_sel_hi:[1,0]
    v_pk_mul_f32 v[38:39], v[38:39], v[4:5] op_sel_hi:[1,0]
    v_pk_mul_f32 v[40:41], v[40:41], v[4:5] op_sel_hi:[1,0]
    v_pk_mul_f32 v[42:43], v[42:43], v[4:5] op_sel_hi:[1,0]
    v_pk_mul_f32 v[44:45], v[44:45], v[4:5] op_sel_hi:[1,0]
    v_pk_mul_f32 v[46:47], v[46:47], v[4:5] op_sel_hi:[1,0]
    v_pk_mul_f32 v[48:49], v[48:49], v[4:5] op_sel_hi:[1,0]
    v_pk_mul_f32 v[56:57], v[56:57], v[4:5] op_sel:[0,1]
    v_pk_mul_f32 v[58:59], v[58:59], v[4:5] op_sel:[0,1]
    v_pk_mul_f32 v[60:61], v[60:61], v[4:5] op_sel:[0,1]
    v_pk_mul_f32 v[62:63], v[62:63], v[4:5] op_sel:[0,1]
    v_pk_mul_f32 v[64:65], v[64:65], v[4:5] op_sel:[0,1]
    v_pk_mul_f32 v[66:67], v[66:67], v[4:5] op_sel:[0,1]
    v_pk_mul_f32 v[68:69], v[68:69], v[4:5] op_sel:[0,1]
    v_cvt_pk_bf16_f32 v36, v36, v37
    v_cvt_pk_bf16_f32 v37, v38, v39
    v_cvt_pk_bf16_f32 v38, v40, v41
    v_cvt_pk_bf16_f32 v39, v42, v43
    v_cvt_pk_bf16_f32 v40, v44, v45
    v_cvt_pk_bf16_f32 v41, v46, v47
    v_cvt_pk_bf16_f32 v42, v48, v49
    v_cvt_pk_bf16_f32 v44, v56, v57
    v_cvt_pk_bf16_f32 v45, v58, v59
    v_cvt_pk_bf16_f32 v46, v60, v61
    v_cvt_pk_bf16_f32 v47, v62, v63
    v_cvt_pk_bf16_f32 v48, v64, v65
    v_cvt_pk_bf16_f32 v49, v66, v67
    v_cvt_pk_bf16_f32 v50, v68, v69
    v_mov_b32 v43, 0
    v_mov_b32 v51, 0
    ds_write_b128 v9, v[72:75]
    ds_write_b128 v10, v[76:79]
    ds_write_b128 v164, v[36:39]
    ds_write_b128 v165, v[40:43]
    ds_write_b128 v166, v[44:47]
    ds_write_b128 v167, v[48:51]
    s_waitcnt lgkmcnt(0)
    v_mfma_f32_32x32x16_bf16 v[88:103], v[152:155], v[24:27], v[88:103]
    v_mfma_f32_32x32x16_bf16 v[104:119], v[156:159], v[24:27], v[104:119]
    v_mfma_f32_32x32x16_bf16 v[120:135], v[160:163], v[24:27], v[120:135]
    s_barrier
    s_nop 8
    v_pk_mul_f32 v[148:149], v[88:89], v[88:89]
    v_pk_mul_f32 v[150:151], v[90:91], v[90:91]
    v_pk_mul_f32 v[152:153], v[92:93], v[92:93]
    v_pk_mul_f32 v[154:155], v[94:95], v[94:95]
    v_pk_fma_f32 v[148:149], v[148:149], v[18:19], v[18:19] op_sel:[0,1,0] op_sel_hi:[1,1,0]
    v_pk_fma_f32 v[150:151], v[150:151], v[18:19], v[18:19] op_sel:[0,1,0] op_sel_hi:[1,1,0]
    v_pk_fma_f32 v[152:153], v[152:153], v[18:19], v[18:19] op_sel:[0,1,0] op_sel_hi:[1,1,0]
    v_pk_fma_f32 v[154:155], v[154:155], v[18:19], v[18:19] op_sel:[0,1,0] op_sel_hi:[1,1,0]
    v_pk_mul_f32 v[148:149], v[148:149], v[88:89]
    v_pk_mul_f32 v[150:151], v[150:151], v[90:91]
    v_pk_mul_f32 v[152:153], v[152:153], v[92:93]
    v_pk_mul_f32 v[154:155], v[154:155], v[94:95]
    v_exp_f32 v148, v148
    v_exp_f32 v149, v149
    v_exp_f32 v150, v150
    v_exp_f32 v151, v151
    v_exp_f32 v152, v152
    v_exp_f32 v153, v153
    v_exp_f32 v154, v154
    v_exp_f32 v155, v155
    v_pk_mul_f32 v[88:89], v[88:89], v[96:97]
    v_pk_mul_f32 v[90:91], v[90:91], v[98:99]
    v_pk_mul_f32 v[92:93], v[92:93], v[100:101]
    v_pk_mul_f32 v[94:95], v[94:95], v[102:103]
    v_pk_fma_f32 v[148:149], v[148:149], v[20:21], v[20:21] op_sel_hi:[1,0,0]
    v_pk_fma_f32 v[150:151], v[150:151], v[20:21], v[20:21] op_sel_hi:[1,0,0]
    v_pk_fma_f32 v[152:153], v[152:153], v[20:21], v[20:21] op_sel_hi:[1,0,0]
    v_pk_fma_f32 v[154:155], v[154:155], v[20:21], v[20:21] op_sel_hi:[1,0,0]
    v_rcp_f32 v148, v148
    v_rcp_f32 v149, v149
    v_rcp_f32 v150, v150
    v_rcp_f32 v151, v151
    v_rcp_f32 v152, v152
    v_rcp_f32 v153, v153
    v_rcp_f32 v154, v154
    v_rcp_f32 v155, v155
    v_pk_mul_f32 v[88:89], v[88:89], v[148:149]
    v_pk_mul_f32 v[90:91], v[90:91], v[150:151]
    v_pk_mul_f32 v[92:93], v[92:93], v[152:153]
    v_pk_mul_f32 v[94:95], v[94:95], v[154:155]
    v_cvt_pk_bf16_f32 v156, v88, v89
    v_cvt_pk_bf16_f32 v157, v90, v91
    v_cvt_pk_bf16_f32 v158, v92, v93
    v_cvt_pk_bf16_f32 v159, v94, v95
    s_add_u32 s87, s83, 0
    buffer_store_dwordx4 v[156:159], v2, s[40:43], s87 offen sc1
    v_pk_mul_f32 v[136:137], v[104:105], v[104:105]
    v_pk_mul_f32 v[138:139], v[106:107], v[106:107]
    v_pk_mul_f32 v[140:141], v[108:109], v[108:109]
    v_pk_mul_f32 v[142:143], v[110:111], v[110:111]
    v_pk_fma_f32 v[136:137], v[136:137], v[18:19], v[18:19] op_sel:[0,1,0] op_sel_hi:[1,1,0]
    v_pk_fma_f32 v[138:139], v[138:139], v[18:19], v[18:19] op_sel:[0,1,0] op_sel_hi:[1,1,0]
    v_pk_fma_f32 v[140:141], v[140:141], v[18:19], v[18:19] op_sel:[0,1,0] op_sel_hi:[1,1,0]
    v_pk_fma_f32 v[142:143], v[142:143], v[18:19], v[18:19] op_sel:[0,1,0] op_sel_hi:[1,1,0]
    v_pk_mul_f32 v[136:137], v[136:137], v[104:105]
    v_pk_mul_f32 v[138:139], v[138:139], v[106:107]
    v_pk_mul_f32 v[140:141], v[140:141], v[108:109]
    v_pk_mul_f32 v[142:143], v[142:143], v[110:111]
    v_exp_f32 v136, v136
    v_exp_f32 v137, v137
    v_exp_f32 v138, v138
    v_exp_f32 v139, v139
    v_exp_f32 v140, v140
    v_exp_f32 v141, v141
    v_exp_f32 v142, v142
    v_exp_f32 v143, v143
    v_pk_mul_f32 v[104:105], v[104:105], v[112:113]
    v_pk_mul_f32 v[106:107], v[106:107], v[114:115]
    v_pk_mul_f32 v[108:109], v[108:109], v[116:117]
    v_pk_mul_f32 v[110:111], v[110:111], v[118:119]
    v_pk_fma_f32 v[136:137], v[136:137], v[20:21], v[20:21] op_sel_hi:[1,0,0]
    v_pk_fma_f32 v[138:139], v[138:139], v[20:21], v[20:21] op_sel_hi:[1,0,0]
    v_pk_fma_f32 v[140:141], v[140:141], v[20:21], v[20:21] op_sel_hi:[1,0,0]
    v_pk_fma_f32 v[142:143], v[142:143], v[20:21], v[20:21] op_sel_hi:[1,0,0]
    v_rcp_f32 v136, v136
    v_rcp_f32 v137, v137
    v_rcp_f32 v138, v138
    v_rcp_f32 v139, v139
    v_rcp_f32 v140, v140
    v_rcp_f32 v141, v141
    v_rcp_f32 v142, v142
    v_rcp_f32 v143, v143
    v_pk_mul_f32 v[104:105], v[104:105], v[136:137]
    v_pk_mul_f32 v[106:107], v[106:107], v[138:139]
    v_pk_mul_f32 v[108:109], v[108:109], v[140:141]
    v_pk_mul_f32 v[110:111], v[110:111], v[142:143]
    v_cvt_pk_bf16_f32 v144, v104, v105
    v_cvt_pk_bf16_f32 v145, v106, v107
    v_cvt_pk_bf16_f32 v146, v108, v109
    v_cvt_pk_bf16_f32 v147, v110, v111
    s_add_u32 s87, s84, 0
    buffer_store_dwordx4 v[144:147], v2, s[40:43], s87 offen sc1
    v_pk_mul_f32 v[148:149], v[120:121], v[120:121]
    v_pk_mul_f32 v[150:151], v[122:123], v[122:123]
    v_pk_mul_f32 v[152:153], v[124:125], v[124:125]
    v_pk_mul_f32 v[154:155], v[126:127], v[126:127]
    v_pk_fma_f32 v[148:149], v[148:149], v[18:19], v[18:19] op_sel:[0,1,0] op_sel_hi:[1,1,0]
    v_pk_fma_f32 v[150:151], v[150:151], v[18:19], v[18:19] op_sel:[0,1,0] op_sel_hi:[1,1,0]
    v_pk_fma_f32 v[152:153], v[152:153], v[18:19], v[18:19] op_sel:[0,1,0] op_sel_hi:[1,1,0]
    v_pk_fma_f32 v[154:155], v[154:155], v[18:19], v[18:19] op_sel:[0,1,0] op_sel_hi:[1,1,0]
    v_pk_mul_f32 v[148:149], v[148:149], v[120:121]
    v_pk_mul_f32 v[150:151], v[150:151], v[122:123]
    v_pk_mul_f32 v[152:153], v[152:153], v[124:125]
    v_pk_mul_f32 v[154:155], v[154:155], v[126:127]
    v_exp_f32 v148, v148
    v_exp_f32 v149, v149
    v_exp_f32 v150, v150
    v_exp_f32 v151, v151
    v_exp_f32 v152, v152
    v_exp_f32 v153, v153
    v_exp_f32 v154, v154
    v_exp_f32 v155, v155
    v_pk_mul_f32 v[120:121], v[120:121], v[128:129]
    v_pk_mul_f32 v[122:123], v[122:123], v[130:131]
    v_pk_mul_f32 v[124:125], v[124:125], v[132:133]
    v_pk_mul_f32 v[126:127], v[126:127], v[134:135]
    v_pk_fma_f32 v[148:149], v[148:149], v[20:21], v[20:21] op_sel_hi:[1,0,0]
    v_pk_fma_f32 v[150:151], v[150:151], v[20:21], v[20:21] op_sel_hi:[1,0,0]
    v_pk_fma_f32 v[152:153], v[152:153], v[20:21], v[20:21] op_sel_hi:[1,0,0]
    v_pk_fma_f32 v[154:155], v[154:155], v[20:21], v[20:21] op_sel_hi:[1,0,0]
    v_rcp_f32 v148, v148
    v_rcp_f32 v149, v149
    v_rcp_f32 v150, v150
    v_rcp_f32 v151, v151
    v_rcp_f32 v152, v152
    v_rcp_f32 v153, v153
    v_rcp_f32 v154, v154
    v_rcp_f32 v155, v155
    v_pk_mul_f32 v[120:121], v[120:121], v[148:149]
    v_pk_mul_f32 v[122:123], v[122:123], v[150:151]
    v_pk_mul_f32 v[124:125], v[124:125], v[152:153]
    v_pk_mul_f32 v[126:127], v[126:127], v[154:155]
    v_cvt_pk_bf16_f32 v156, v120, v121
    v_cvt_pk_bf16_f32 v157, v122, v123
    v_cvt_pk_bf16_f32 v158, v124, v125
    v_cvt_pk_bf16_f32 v159, v126, v127
    s_add_u32 s87, s84, 1024
    buffer_store_dwordx4 v[156:159], v2, s[40:43], s87 offen sc1
    v_lshrrev_b32 v16, 3, v1
    v_mul_u32_u24 v17, 896, v16
    v_sub_u32 v17, v11, v17
    v_lshrrev_b32 v18, 2, v16
    v_and_b32 v19, 3, v16
    v_mad_u32_u24 v18, v18, 14, v19
    v_mul_u32_u24 v4, 896, v18
    v_add_u32 v4, v4, v17
    v_cmp_lt_u32_e64 s[88:89], 1, v19
    v_mov_b32 v18, 0x7f000000
    s_nop 0
    v_cndmask_b32_e64 v5, v4, v18, s[88:89]
    s_and_b32 s77, s3, 1
    s_bfe_u32 s78, s3, 0x10001
    s_lshr_b32 s79, s3, 2
    s_lshl_b32 s74, s65, 1
    s_add_u32 s74, s74, s77
    s_mul_i32 s75, s74, 147456
    v_add_u32 v6, s75, v2
    s_xor_b32 s76, s74, 1
    s_mul_i32 s76, s76, 147456
    v_add_u32 v7, s76, v2
    v_mov_b32 v9, s75
    v_mov_b32 v10, s76
    v_cmp_lt_u32_e64 s[88:89], 15, v1
    s_nop 1
    v_cndmask_b32_e64 v9, v9, v10, s[88:89]
    v_and_b32 v10, 3, v1
    v_lshl_add_u32 v9, v10, 10, v9
    v_lshrrev_b32 v17, 5, v1
    v_and_b32 v16, 31, v1
    s_lshl_b32 s74, s74, 5
    v_add_u32 v16, s74, v16
    v_mul_u32_u24 v16, 896, v16
    v_lshlrev_b32 v17, 5, v17
    s_lshl_b32 s74, s66, 7
    s_lshl_b32 s75, s78, 6
    s_add_u32 s74, s74, s75
    s_lshl_b32 s75, s79, 4
    s_add_u32 s74, s74, s75
    v_add3_u32 v8, v16, v17, s74
    s_mul_i32 s71, s72, 50176
    s_mul_i32 s83, s72, 14336
    s_lshl_b32 s84, s72, 12
    s_add_u32 s84, s84, 100352
    s_add_u32 s87, s84, 15344
    v_mov_b32 v16, 161804
K_kv_zone:
    ds_read_b32 v17, v16
    s_waitcnt lgkmcnt(0)
    v_readfirstlane_b32 s75, v17
    s_nop 0
    s_cmp_lt_u32 s75, 4
    s_cbranch_scc1 K_kv_zone
    s_waitcnt vmcnt(0)
    v_mov_b32 v16, 161800
    v_mov_b32 v17, 1
    s_mov_b64 exec, 1
    ds_add_rtn_u32 v18, v16, v17
    s_mov_b64 exec, -1
    s_waitcnt lgkmcnt(0)
    v_readfirstlane_b32 s75, v18
    s_nop 0
    s_cmp_lg_u32 s75, 7
    s_cbranch_scc1 K_kv_nosigh
    s_and_b32 s75, s64, 3
    s_lshl_b32 s75, s75, 1
    s_lshr_b32 s76, s64, 2
    s_add_u32 s75, s75, s76
    s_mul_i32 s75, s75, 4352
    s_bfe_u32 s76, s86, 0x50003
    s_lshl_b32 s76, s76, 2
    s_add_u32 s75, s75, s76
    s_add_u32 s75, s75, 14680064
    v_mul_u32_u24 v18, 34816, v1
    v_mov_b32 v17, s98
    s_mov_b64 exec, 0xfffffff
    s_nop 1
    buffer_store_dword v17, v18, s[40:43], s75 offen sc1
    s_mov_b64 exec, -1
K_kv_nosigh:
    s_cmp_ge_u32 s2, 224
    s_cbranch_scc1 K_kv_fin
    s_and_b32 s74, s72, 6
    s_lshr_b32 s75, s73, 2
    s_add_u32 s74, s74, s75
    s_lshl_b32 s74, s74, 2
    s_add_u32 s74, s74, 162048
    v_mov_b32 v24, s74
    ds_read_b32 v24, v24
    s_waitcnt lgkmcnt(0)
    v_readfirstlane_b32 s54, v24
    s_mul_i32 s52, s2, 4352
    s_add_u32 s52, s52, 14680064
    s_lshr_b32 s74, s72, 1
    s_lshl_b32 s74, s74, 3
    s_cmp_lt_u32 s3, 4
    s_movk_i32 s53, 0xff
    s_cselect_b32 s53, 0x55, s53
    s_lshl_b32 s53, s53, s74
    s_mov_b32 s77, 0
    v_min_u32 v24, 32, v1
    v_lshlrev_b32 v24, 2, v24
    v_add_u32 v25, 161856, v24
    v_and_b32 v24, 0x7c, v24
    v_mov_b32 v14, 161812
K_kv_a1:
    ds_read_b32 v15, v14
    s_waitcnt lgkmcnt(0)
    v_readfirstlane_b32 s75, v15
    s_nop 0
    s_cmp_lt_u32 s75, 4
    s_cbranch_scc1 K_kv_a1
    ds_read_b64_tr_b16 v[56:57], v12 offset:0
    ds_read_b64_tr_b16 v[58:59], v12 offset:1024
    ds_read_b64_tr_b16 v[60:61], v13 offset:0
    ds_read_b64_tr_b16 v[62:63], v13 offset:1024
    ds_read_b64_tr_b16 v[64:65], v12 offset:2048
    ds_read_b64_tr_b16 v[66:67], v12 offset:3072
    ds_read_b64_tr_b16 v[68:69], v13 offset:2048
    ds_read_b64_tr_b16 v[70:71], v13 offset:3072
    ds_read_b64_tr_b16 v[72:73], v12 offset:4096
    ds_read_b64_tr_b16 v[74:75], v12 offset:5120
    ds_read_b64_tr_b16 v[76:77], v13 offset:4096
    ds_read_b64_tr_b16 v[78:79], v13 offset:5120
    ds_read_b64_tr_b16 v[80:81], v12 offset:6144
    ds_read_b64_tr_b16 v[82:83], v12 offset:7168
    ds_read_b64_tr_b16 v[84:85], v13 offset:6144
    ds_read_b64_tr_b16 v[86:87], v13 offset:7168
    ds_read_b64_tr_b16 v[88:89], v12 offset:8192
    ds_read_b64_tr_b16 v[90:91], v12 offset:9216
    ds_read_b64_tr_b16 v[92:93], v13 offset:8192
    ds_read_b64_tr_b16 v[94:95], v13 offset:9216
    ds_read_b64_tr_b16 v[96:97], v12 offset:10240
    ds_read_b64_tr_b16 v[98:99], v12 offset:11264
    ds_read_b64_tr_b16 v[100:101], v13 offset:10240
    ds_read_b64_tr_b16 v[102:103], v13 offset:11264
    s_waitcnt lgkmcnt(0)
    s_add_u32 m0, s70, 0
    s_add_u32 s85, s69, 86016
    buffer_load_dwordx4 v11, s[56:59], s85 offen lds
    s_add_u32 m0, s70, 1024
    s_add_u32 s85, s69, 93184
    buffer_load_dwordx4 v11, s[56:59], s85 offen lds
    s_add_u32 m0, s70, 2048
    s_add_u32 s85, s69, 100352
    buffer_load_dwordx4 v11, s[56:59], s85 offen lds
    s_add_u32 m0, s70, 3072
    s_add_u32 s85, s69, 107520
    buffer_load_dwordx4 v11, s[56:59], s85 offen lds
    s_add_u32 m0, s70, 4096
    s_add_u32 s85, s69, 114688
    buffer_load_dwordx4 v11, s[56:59], s85 offen lds
    s_add_u32 m0, s70, 5120
    s_add_u32 s85, s69, 121856
    buffer_load_dwordx4 v11, s[56:59], s85 offen lds
    s_add_u32 m0, s70, 6144
    s_add_u32 s85, s69, 129024
    buffer_load_dwordx4 v11, s[56:59], s85 offen lds
    s_add_u32 m0, s70, 7168
    s_add_u32 s85, s69, 136192
    buffer_load_dwordx4 v11, s[56:59], s85 offen lds
    s_add_u32 m0, s70, 8192
    s_add_u32 s85, s69, 143360
    buffer_load_dwordx4 v11, s[56:59], s85 offen lds
    s_add_u32 m0, s70, 9216
    s_add_u32 s85, s69, 150528
    buffer_load_dwordx4 v11, s[56:59], s85 offen lds
    s_add_u32 m0, s70, 10240
    s_add_u32 s85, s69, 157696
    buffer_load_dwordx4 v11, s[56:59], s85 offen lds
    s_add_u32 m0, s70, 11264
    s_add_u32 s85, s69, 164864
    buffer_load_dwordx4 v11, s[56:59], s85 offen lds
    s_add_u32 m0, s70, 12288
    s_add_u32 s85, s69, 172032
    buffer_load_dwordx4 v11, s[56:59], s85 offen lds
    s_add_u32 m0, s70, 13312
    s_add_u32 s85, s69, 179200
    buffer_load_dwordx4 v11, s[56:59], s85 offen lds
    s_add_u32 m0, s70, 14336
    s_add_u32 s85, s69, 186368
    buffer_load_dwordx4 v11, s[56:59], s85 offen lds
    s_add_u32 m0, s70, 15360
    s_add_u32 s85, s69, 193536
    buffer_load_dwordx4 v11, s[56:59], s85 offen lds
    s_add_u32 m0, s70, 16384
    s_add_u32 s85, s71, 0
    buffer_load_dwordx4 v4, s[60:63], s85 offen lds
    s_add_u32 m0, s70, 17408
    s_add_u32 s85, s71, 3584
    buffer_load_dwordx4 v4, s[60:63], s85 offen lds
    s_mov_b32 s77, 0
    s_cmp_eq_u32 s3, 7
    s_cbranch_scc1 K_kv_phg
K_kv_phl:
    ds_read_b32 v14, v25
    s_waitcnt lgkmcnt(0)
    s_waitcnt lgkmcnt(0)
    v_cmp_ne_u32_e64 s[88:89], s54, v14
    s_waitcnt lgkmcnt(0)
    v_readlane_b32 s75, v14, 32
    s_nop 0
    s_and_b32 s85, s88, s53
    s_cbranch_scc0 K_kv_phok
    s_sleep 2
    s_nop 0
    s_cmp_eq_u32 s75, 0
    s_cbranch_scc1 K_kv_phl
K_kv_phg:
    s_waitcnt lgkmcnt(0)
    buffer_load_dword v14, v24, s[40:43], s52 offen sc1
    s_waitcnt vmcnt(0)
    s_mov_b32 exec_hi, 0
    s_waitcnt vmcnt(0) lgkmcnt(0)
    ds_write_b32 v25, v14
    s_mov_b32 exec_hi, -1
    s_waitcnt vmcnt(0) lgkmcnt(0)
    v_cmp_ne_u32_e64 s[88:89], s54, v14
    s_add_u32 s77, s77, 1
    s_nop 0
    s_and_b32 s85, s88, s53
    s_cbranch_scc0 K_kv_phd
    s_sleep 4
    s_cmp_lt_u32 s77, 0x8000
    s_cbranch_scc1 K_kv_phg
K_kv_phd:
    s_waitcnt vmcnt(0) lgkmcnt(0)
    v_mov_b32 v14, 161984
    v_mov_b32 v15, 1
    s_waitcnt vmcnt(0) lgkmcnt(0)
    ds_write_b32 v14, v15
K_kv_phok:
    s_add_u32 s85, s83, 0
    buffer_load_dwordx4 v[16:19], v6, s[40:43], s85 offen sc1
    buffer_load_dwordx4 v[20:23], v7, s[40:43], s85 offen sc1
    s_add_u32 s85, s83, 1024
    buffer_load_dwordx4 v[24:27], v6, s[40:43], s85 offen sc1
    buffer_load_dwordx4 v[28:31], v7, s[40:43], s85 offen sc1
    s_add_u32 s85, s83, 2048
    buffer_load_dwordx4 v[32:35], v6, s[40:43], s85 offen sc1
    buffer_load_dwordx4 v[36:39], v7, s[40:43], s85 offen sc1
    s_add_u32 s85, s83, 3072
    buffer_load_dwordx4 v[40:43], v6, s[40:43], s85 offen sc1
    buffer_load_dwordx4 v[44:47], v7, s[40:43], s85 offen sc1
    s_add_u32 s85, s83, 4096
    buffer_load_dwordx4 v[48:51], v6, s[40:43], s85 offen sc1
    buffer_load_dwordx4 v[52:55], v7, s[40:43], s85 offen sc1
    s_waitcnt vmcnt(9)
    v_mfma_f32_32x32x16_bf16 v[104:119], v[56:59], v[16:19], 0
    s_waitcnt vmcnt(8)
    v_mfma_f32_32x32x16_bf16 v[120:135], v[56:59], v[20:23], 0
    v_mfma_f32_32x32x16_bf16 v[136:151], v[60:63], v[16:19], 0
    v_mfma_f32_32x32x16_bf16 v[152:167], v[60:63], v[20:23], 0
    s_add_u32 s85, s83, 5120
    buffer_load_dwordx4 v[16:19], v6, s[40:43], s85 offen sc1
    buffer_load_dwordx4 v[20:23], v7, s[40:43], s85 offen sc1
    s_add_u32 s85, s83, 6144
    buffer_load_dwordx4 v[56:59], v6, s[40:43], s85 offen sc1
    buffer_load_dwordx4 v[60:63], v7, s[40:43], s85 offen sc1
    s_waitcnt vmcnt(11)
    v_mfma_f32_32x32x16_bf16 v[104:119], v[64:67], v[24:27], v[104:119]
    s_waitcnt vmcnt(10)
    v_mfma_f32_32x32x16_bf16 v[120:135], v[64:67], v[28:31], v[120:135]
    v_mfma_f32_32x32x16_bf16 v[136:151], v[68:71], v[24:27], v[136:151]
    v_mfma_f32_32x32x16_bf16 v[152:167], v[68:71], v[28:31], v[152:167]
    s_add_u32 s85, s83, 7168
    buffer_load_dwordx4 v[24:27], v6, s[40:43], s85 offen sc1
    buffer_load_dwordx4 v[28:31], v7, s[40:43], s85 offen sc1
    s_add_u32 s85, s83, 8192
    buffer_load_dwordx4 v[64:67], v6, s[40:43], s85 offen sc1
    buffer_load_dwordx4 v[68:71], v7, s[40:43], s85 offen sc1
    s_waitcnt vmcnt(13)
    v_mfma_f32_32x32x16_bf16 v[104:119], v[72:75], v[32:35], v[104:119]
    s_waitcnt vmcnt(12)
    v_mfma_f32_32x32x16_bf16 v[120:135], v[72:75], v[36:39], v[120:135]
    v_mfma_f32_32x32x16_bf16 v[136:151], v[76:79], v[32:35], v[136:151]
    v_mfma_f32_32x32x16_bf16 v[152:167], v[76:79], v[36:39], v[152:167]
    s_add_u32 s85, s83, 9216
    buffer_load_dwordx4 v[32:35], v6, s[40:43], s85 offen sc1
    buffer_load_dwordx4 v[36:39], v7, s[40:43], s85 offen sc1
    s_add_u32 s85, s83, 10240
    buffer_load_dwordx4 v[72:75], v6, s[40:43], s85 offen sc1
    buffer_load_dwordx4 v[76:79], v7, s[40:43], s85 offen sc1
    s_waitcnt vmcnt(15)
    v_mfma_f32_32x32x16_bf16 v[104:119], v[80:83], v[40:43], v[104:119]
    s_waitcnt vmcnt(14)
    v_mfma_f32_32x32x16_bf16 v[120:135], v[80:83], v[44:47], v[120:135]
    v_mfma_f32_32x32x16_bf16 v[136:151], v[84:87], v[40:43], v[136:151]
    v_mfma_f32_32x32x16_bf16 v[152:167], v[84:87], v[44:47], v[152:167]
    s_add_u32 s85, s83, 11264
    buffer_load_dwordx4 v[40:43], v6, s[40:43], s85 offen sc1
    buffer_load_dwordx4 v[44:47], v7, s[40:43], s85 offen sc1
    s_waitcnt vmcnt(15)
    v_mfma_f32_32x32x16_bf16 v[104:119], v[88:91], v[48:51], v[104:119]
    s_waitcnt vmcnt(14)
    v_mfma_f32_32x32x16_bf16 v[120:135], v[88:91], v[52:55], v[120:135]
    v_mfma_f32_32x32x16_bf16 v[136:151], v[92:95], v[48:51], v[136:151]
    v_mfma_f32_32x32x16_bf16 v[152:167], v[92:95], v[52:55], v[152:167]
    s_add_u32 s85, s83, 12288
    buffer_load_dwordx4 v[48:51], v6, s[40:43], s85 offen sc1
    buffer_load_dwordx4 v[52:55], v7, s[40:43], s85 offen sc1
    ds_read_b64_tr_b16 v[80:81], v12 offset:0
    ds_read_b64_tr_b16 v[82:83], v12 offset:1024
    ds_read_b64_tr_b16 v[84:85], v13 offset:0
    ds_read_b64_tr_b16 v[86:87], v13 offset:1024
    s_waitcnt vmcnt(15)
    v_mfma_f32_32x32x16_bf16 v[104:119], v[96:99], v[16:19], v[104:119]
    s_waitcnt vmcnt(14)
    v_mfma_f32_32x32x16_bf16 v[120:135], v[96:99], v[20:23], v[120:135]
    v_mfma_f32_32x32x16_bf16 v[136:151], v[100:103], v[16:19], v[136:151]
    v_mfma_f32_32x32x16_bf16 v[152:167], v[100:103], v[20:23], v[152:167]
    s_add_u32 s85, s83, 13312
    buffer_load_dwordx4 v[16:19], v6, s[40:43], s85 offen sc1
    buffer_load_dwordx4 v[20:23], v7, s[40:43], s85 offen sc1
    ds_read_b64_tr_b16 v[88:89], v12 offset:2048
    ds_read_b64_tr_b16 v[90:91], v12 offset:3072
    ds_read_b64_tr_b16 v[92:93], v13 offset:2048
    ds_read_b64_tr_b16 v[94:95], v13 offset:3072
    s_waitcnt vmcnt(15) lgkmcnt(6)
    v_mfma_f32_32x32x16_bf16 v[104:119], v[80:83], v[56:59], v[104:119]
    s_waitcnt vmcnt(14)
    v_mfma_f32_32x32x16_bf16 v[120:135], v[80:83], v[60:63], v[120:135]
    s_waitcnt lgkmcnt(4)
    v_mfma_f32_32x32x16_bf16 v[136:151], v[84:87], v[56:59], v[136:151]
    v_mfma_f32_32x32x16_bf16 v[152:167], v[84:87], v[60:63], v[152:167]
    ds_read_b64_tr_b16 v[80:81], v12 offset:4096
    ds_read_b64_tr_b16 v[82:83], v12 offset:5120
    ds_read_b64_tr_b16 v[84:85], v13 offset:4096
    ds_read_b64_tr_b16 v[86:87], v13 offset:5120
    s_waitcnt vmcnt(13) lgkmcnt(6)
    v_mfma_f32_32x32x16_bf16 v[104:119], v[88:91], v[24:27], v[104:119]
    s_waitcnt vmcnt(12)
    v_mfma_f32_32x32x16_bf16 v[120:135], v[88:91], v[28:31], v[120:135]
    s_waitcnt lgkmcnt(4)
    v_mfma_f32_32x32x16_bf16 v[136:151], v[92:95], v[24:27], v[136:151]
    v_mfma_f32_32x32x16_bf16 v[152:167], v[92:95], v[28:31], v[152:167]
    s_add_u32 m0, s70, 0
    s_add_u32 s85, s71, 7168
    buffer_load_dwordx4 v4, s[60:63], s85 offen lds
    s_add_u32 m0, s70, 1024
    s_add_u32 s85, s71, 10752
    buffer_load_dwordx4 v5, s[60:63], s85 offen lds
    ds_read_b64_tr_b16 v[88:89], v12 offset:6144
    ds_read_b64_tr_b16 v[90:91], v12 offset:7168
    ds_read_b64_tr_b16 v[92:93], v13 offset:6144
    ds_read_b64_tr_b16 v[94:95], v13 offset:7168
    s_waitcnt vmcnt(13) lgkmcnt(6)
    v_mfma_f32_32x32x16_bf16 v[104:119], v[80:83], v[64:67], v[104:119]
    s_waitcnt vmcnt(12)
    v_mfma_f32_32x32x16_bf16 v[120:135], v[80:83], v[68:71], v[120:135]
    s_waitcnt lgkmcnt(4)
    v_mfma_f32_32x32x16_bf16 v[136:151], v[84:87], v[64:67], v[136:151]
    v_mfma_f32_32x32x16_bf16 v[152:167], v[84:87], v[68:71], v[152:167]
    s_add_u32 m0, s70, 2048
    s_add_u32 s85, s71, 25088
    buffer_load_dwordx4 v4, s[60:63], s85 offen lds
    s_add_u32 m0, s70, 3072
    s_add_u32 s85, s71, 28672
    buffer_load_dwordx4 v4, s[60:63], s85 offen lds
    ds_read_b64_tr_b16 v[80:81], v12 offset:8192
    ds_read_b64_tr_b16 v[82:83], v12 offset:9216
    ds_read_b64_tr_b16 v[84:85], v13 offset:8192
    ds_read_b64_tr_b16 v[86:87], v13 offset:9216
    s_waitcnt vmcnt(13) lgkmcnt(6)
    v_mfma_f32_32x32x16_bf16 v[104:119], v[88:91], v[32:35], v[104:119]
    s_waitcnt vmcnt(12)
    v_mfma_f32_32x32x16_bf16 v[120:135], v[88:91], v[36:39], v[120:135]
    s_waitcnt lgkmcnt(4)
    v_mfma_f32_32x32x16_bf16 v[136:151], v[92:95], v[32:35], v[136:151]
    v_mfma_f32_32x32x16_bf16 v[152:167], v[92:95], v[36:39], v[152:167]
    s_add_u32 m0, s70, 4096
    s_add_u32 s85, s71, 32256
    buffer_load_dwordx4 v4, s[60:63], s85 offen lds
    s_add_u32 m0, s70, 5120
    s_add_u32 s85, s71, 35840
    buffer_load_dwordx4 v5, s[60:63], s85 offen lds
    ds_read_b64_tr_b16 v[88:89], v12 offset:10240
    ds_read_b64_tr_b16 v[90:91], v12 offset:11264
    ds_read_b64_tr_b16 v[92:93], v13 offset:10240
    ds_read_b64_tr_b16 v[94:95], v13 offset:11264
    s_waitcnt vmcnt(13) lgkmcnt(6)
    v_mfma_f32_32x32x16_bf16 v[104:119], v[80:83], v[72:75], v[104:119]
    s_waitcnt vmcnt(12)
    v_mfma_f32_32x32x16_bf16 v[120:135], v[80:83], v[76:79], v[120:135]
    s_waitcnt lgkmcnt(4)
    v_mfma_f32_32x32x16_bf16 v[136:151], v[84:87], v[72:75], v[136:151]
    v_mfma_f32_32x32x16_bf16 v[152:167], v[84:87], v[76:79], v[152:167]
    buffer_load_dword v14, v9, s[40:43], s87 offen sc1
    ds_read_b64_tr_b16 v[80:81], v12 offset:12288
    ds_read_b64_tr_b16 v[82:83], v12 offset:13312
    ds_read_b64_tr_b16 v[84:85], v13 offset:12288
    ds_read_b64_tr_b16 v[86:87], v13 offset:13312
    s_waitcnt vmcnt(12) lgkmcnt(6)
    v_mfma_f32_32x32x16_bf16 v[104:119], v[88:91], v[40:43], v[104:119]
    s_waitcnt vmcnt(11)
    v_mfma_f32_32x32x16_bf16 v[120:135], v[88:91], v[44:47], v[120:135]
    s_waitcnt lgkmcnt(4)
    v_mfma_f32_32x32x16_bf16 v[136:151], v[92:95], v[40:43], v[136:151]
    v_mfma_f32_32x32x16_bf16 v[152:167], v[92:95], v[44:47], v[152:167]
    ds_read_b64_tr_b16 v[88:89], v12 offset:14336
    ds_read_b64_tr_b16 v[90:91], v12 offset:15360
    ds_read_b64_tr_b16 v[92:93], v13 offset:14336
    ds_read_b64_tr_b16 v[94:95], v13 offset:15360
    s_waitcnt vmcnt(10) lgkmcnt(6)
    v_mfma_f32_32x32x16_bf16 v[104:119], v[80:83], v[48:51], v[104:119]
    s_waitcnt vmcnt(9)
    v_mfma_f32_32x32x16_bf16 v[120:135], v[80:83], v[52:55], v[120:135]
    s_waitcnt lgkmcnt(4)
    v_mfma_f32_32x32x16_bf16 v[136:151], v[84:87], v[48:51], v[136:151]
    v_mfma_f32_32x32x16_bf16 v[152:167], v[84:87], v[52:55], v[152:167]
    s_waitcnt vmcnt(0)
    v_cmp_eq_u32_e64 s[88:89], -1, v14
    s_mov_b32 s77, 0
    s_cmp_eq_u64 s[88:89], 0
    s_cbranch_scc1 K_kv_po_ok
K_kv_po_loop:
    buffer_load_dword v14, v9, s[40:43], s87 offen sc1
    s_waitcnt vmcnt(0)
    s_waitcnt vmcnt(0)
    v_cmp_eq_u32_e64 s[88:89], -1, v14
    s_add_u32 s77, s77, 1
    s_nop 0
    s_cmp_eq_u64 s[88:89], 0
    s_cbranch_scc1 K_kv_po_ok
    s_sleep 4
    s_cmp_lt_u32 s77, 0x8000
    s_cbranch_scc1 K_kv_po_loop
K_kv_po_ok:
    s_add_u32 s85, s84, 14336
    buffer_load_dwordx4 v[96:99], v6, s[40:43], s85 offen sc1
    buffer_load_dwordx4 v[100:103], v7, s[40:43], s85 offen sc1
    s_add_u32 s85, s84, 15360
    buffer_load_dwordx4 v[56:59], v6, s[40:43], s85 offen sc1
    buffer_load_dwordx4 v[60:63], v7, s[40:43], s85 offen sc1
    s_add_u32 s85, s84, 16384
    buffer_load_dwordx4 v[24:27], v6, s[40:43], s85 offen sc1
    buffer_load_dwordx4 v[28:31], v7, s[40:43], s85 offen sc1
    s_add_u32 s85, s84, 17408
    buffer_load_dwordx4 v[64:67], v6, s[40:43], s85 offen sc1
    buffer_load_dwordx4 v[68:71], v7, s[40:43], s85 offen sc1
    ds_read_b64_tr_b16 v[80:81], v12 offset:16384
    ds_read_b64_tr_b16 v[82:83], v12 offset:17408
    ds_read_b64_tr_b16 v[84:85], v13 offset:16384
    ds_read_b64_tr_b16 v[86:87], v13 offset:17408
    s_waitcnt lgkmcnt(6)
    v_mfma_f32_32x32x16_bf16 v[104:119], v[88:91], v[16:19], v[104:119]
    v_mfma_f32_32x32x16_bf16 v[120:135], v[88:91], v[20:23], v[120:135]
    s_waitcnt lgkmcnt(4)
    v_mfma_f32_32x32x16_bf16 v[136:151], v[92:95], v[16:19], v[136:151]
    v_mfma_f32_32x32x16_bf16 v[152:167], v[92:95], v[20:23], v[152:167]
    ds_read_b64_tr_b16 v[88:89], v12 offset:0
    ds_read_b64_tr_b16 v[90:91], v12 offset:1024
    ds_read_b64_tr_b16 v[92:93], v13 offset:0
    ds_read_b64_tr_b16 v[94:95], v13 offset:1024
    s_waitcnt vmcnt(7)
    v_max3_u32 v15, v96, v97, v98
    s_waitcnt vmcnt(6)
    v_max3_u32 v15, v15, v99, v100
    v_max3_u32 v15, v15, v101, v102
    v_max_u32 v15, v15, v103
    v_cmp_eq_u32_e64 s[88:89], -1, v15
    s_nop 0
    s_cmp_eq_u64 s[88:89], 0
    s_cbranch_scc1 K_kv_bok14
    s_mov_b32 s77, 0
K_kv_bre14:
    s_add_u32 s85, s84, 14336
    buffer_load_dwordx4 v[96:99], v6, s[40:43], s85 offen sc1
    buffer_load_dwordx4 v[100:103], v7, s[40:43], s85 offen sc1
    s_waitcnt vmcnt(0)
    s_waitcnt vmcnt(0)
    v_max3_u32 v15, v96, v97, v98
    s_waitcnt vmcnt(0)
    v_max3_u32 v15, v15, v99, v100
    s_waitcnt vmcnt(0)
    v_max3_u32 v15, v15, v101, v102
    s_waitcnt vmcnt(0)
    v_max_u32 v15, v15, v103
    v_cmp_eq_u32_e64 s[88:89], -1, v15
    s_add_u32 s77, s77, 1
    s_nop 0
    s_cmp_eq_u64 s[88:89], 0
    s_cbranch_scc1 K_kv_bok14
    s_cmp_lt_u32 s77, 0x4000
    s_cbranch_scc1 K_kv_bre14
K_kv_bok14:
    s_waitcnt lgkmcnt(6)
    v_mfma_f32_32x32x16_bf16 v[104:119], v[80:83], v[96:99], v[104:119]
    v_mfma_f32_32x32x16_bf16 v[120:135], v[80:83], v[100:103], v[120:135]
    s_waitcnt lgkmcnt(4)
    v_mfma_f32_32x32x16_bf16 v[136:151], v[84:87], v[96:99], v[136:151]
    v_mfma_f32_32x32x16_bf16 v[152:167], v[84:87], v[100:103], v[152:167]
    ds_read_b64_tr_b16 v[80:81], v12 offset:2048
    ds_read_b64_tr_b16 v[82:83], v12 offset:3072
    ds_read_b64_tr_b16 v[84:85], v13 offset:2048
    ds_read_b64_tr_b16 v[86:87], v13 offset:3072
    s_waitcnt vmcnt(5)
    v_max3_u32 v15, v56, v57, v58
    s_waitcnt vmcnt(4)
    v_max3_u32 v15, v15, v59, v60
    v_max3_u32 v15, v15, v61, v62
    v_max_u32 v15, v15, v63
    v_cmp_eq_u32_e64 s[88:89], -1, v15
    s_nop 0
    s_cmp_eq_u64 s[88:89], 0
    s_cbranch_scc1 K_kv_bok15
    s_mov_b32 s77, 0
K_kv_bre15:
    s_add_u32 s85, s84, 15360
    buffer_load_dwordx4 v[56:59], v6, s[40:43], s85 offen sc1
    buffer_load_dwordx4 v[60:63], v7, s[40:43], s85 offen sc1
    s_waitcnt vmcnt(0)
    s_waitcnt vmcnt(0)
    v_max3_u32 v15, v56, v57, v58
    s_waitcnt vmcnt(0)
    v_max3_u32 v15, v15, v59, v60
    s_waitcnt vmcnt(0)
    v_max3_u32 v15, v15, v61, v62
    s_waitcnt vmcnt(0)
    v_max_u32 v15, v15, v63
    v_cmp_eq_u32_e64 s[88:89], -1, v15
    s_add_u32 s77, s77, 1
    s_nop 0
    s_cmp_eq_u64 s[88:89], 0
    s_cbranch_scc1 K_kv_bok15
    s_cmp_lt_u32 s77, 0x4000
    s_cbranch_scc1 K_kv_bre15
K_kv_bok15:
    s_waitcnt lgkmcnt(6)
    v_mfma_f32_32x32x16_bf16 v[104:119], v[88:91], v[56:59], v[104:119]
    v_mfma_f32_32x32x16_bf16 v[120:135], v[88:91], v[60:63], v[120:135]
    s_waitcnt lgkmcnt(4)
    v_mfma_f32_32x32x16_bf16 v[136:151], v[92:95], v[56:59], v[136:151]
    v_mfma_f32_32x32x16_bf16 v[152:167], v[92:95], v[60:63], v[152:167]
    buffer_load_dwordx4 v[96:99], v8, s[24:27], 0 offen
    ds_read_b64_tr_b16 v[88:89], v12 offset:4096
    ds_read_b64_tr_b16 v[90:91], v12 offset:5120
    ds_read_b64_tr_b16 v[92:93], v13 offset:4096
    ds_read_b64_tr_b16 v[94:95], v13 offset:5120
    s_waitcnt vmcnt(4)
    v_max3_u32 v15, v24, v25, v26
    s_waitcnt vmcnt(3)
    v_max3_u32 v15, v15, v27, v28
    v_max3_u32 v15, v15, v29, v30
    v_max_u32 v15, v15, v31
    v_cmp_eq_u32_e64 s[88:89], -1, v15
    s_nop 0
    s_cmp_eq_u64 s[88:89], 0
    s_cbranch_scc1 K_kv_bok16
    s_mov_b32 s77, 0
K_kv_bre16:
    s_add_u32 s85, s84, 16384
    buffer_load_dwordx4 v[24:27], v6, s[40:43], s85 offen sc1
    buffer_load_dwordx4 v[28:31], v7, s[40:43], s85 offen sc1
    s_waitcnt vmcnt(0)
    s_waitcnt vmcnt(0)
    v_max3_u32 v15, v24, v25, v26
    s_waitcnt vmcnt(0)
    v_max3_u32 v15, v15, v27, v28
    s_waitcnt vmcnt(0)
    v_max3_u32 v15, v15, v29, v30
    s_waitcnt vmcnt(0)
    v_max_u32 v15, v15, v31
    v_cmp_eq_u32_e64 s[88:89], -1, v15
    s_add_u32 s77, s77, 1
    s_nop 0
    s_cmp_eq_u64 s[88:89], 0
    s_cbranch_scc1 K_kv_bok16
    s_cmp_lt_u32 s77, 0x4000
    s_cbranch_scc1 K_kv_bre16
K_kv_bok16:
    s_waitcnt lgkmcnt(6)
    v_mfma_f32_32x32x16_bf16 v[104:119], v[80:83], v[24:27], v[104:119]
    v_mfma_f32_32x32x16_bf16 v[120:135], v[80:83], v[28:31], v[120:135]
    s_waitcnt lgkmcnt(4)
    v_mfma_f32_32x32x16_bf16 v[136:151], v[84:87], v[24:27], v[136:151]
    v_mfma_f32_32x32x16_bf16 v[152:167], v[84:87], v[28:31], v[152:167]
    s_waitcnt vmcnt(2)
    v_max3_u32 v15, v64, v65, v66
    s_waitcnt vmcnt(1)
    v_max3_u32 v15, v15, v67, v68
    v_max3_u32 v15, v15, v69, v70
    v_max_u32 v15, v15, v71
    v_cmp_eq_u32_e64 s[88:89], -1, v15
    s_nop 0
    s_cmp_eq_u64 s[88:89], 0
    s_cbranch_scc1 K_kv_bok17
    s_mov_b32 s77, 0
K_kv_bre17:
    s_add_u32 s85, s84, 17408
    buffer_load_dwordx4 v[64:67], v6, s[40:43], s85 offen sc1
    buffer_load_dwordx4 v[68:71], v7, s[40:43], s85 offen sc1
    s_waitcnt vmcnt(0)
    s_waitcnt vmcnt(0)
    v_max3_u32 v15, v64, v65, v66
    s_waitcnt vmcnt(0)
    v_max3_u32 v15, v15, v67, v68
    s_waitcnt vmcnt(0)
    v_max3_u32 v15, v15, v69, v70
    s_waitcnt vmcnt(0)
    v_max_u32 v15, v15, v71
    v_cmp_eq_u32_e64 s[88:89], -1, v15
    s_add_u32 s77, s77, 1
    s_nop 0
    s_cmp_eq_u64 s[88:89], 0
    s_cbranch_scc1 K_kv_bok17
    s_cmp_lt_u32 s77, 0x4000
    s_cbranch_scc1 K_kv_bre17
K_kv_bok17:
    s_waitcnt lgkmcnt(2)
    v_mfma_f32_32x32x16_bf16 v[104:119], v[88:91], v[64:67], v[104:119]
    v_mfma_f32_32x32x16_bf16 v[120:135], v[88:91], v[68:71], v[120:135]
    s_waitcnt lgkmcnt(0)
    v_mfma_f32_32x32x16_bf16 v[136:151], v[92:95], v[64:67], v[136:151]
    v_mfma_f32_32x32x16_bf16 v[152:167], v[92:95], v[68:71], v[152:167]
    v_add_u32 v4, s70, v2
    s_nop 7
    ds_write_b128 v4, v[120:123] offset:0
    ds_write_b128 v4, v[124:127] offset:1024
    ds_write_b128 v4, v[136:139] offset:2048
    ds_write_b128 v4, v[140:143] offset:3072
    ds_write_b128 v4, v[152:155] offset:4096
    ds_write_b128 v4, v[156:159] offset:5120
    ds_write_b128 v4, v[112:115] offset:6144
    ds_write_b128 v4, v[116:119] offset:7168
    ds_write_b128 v4, v[128:131] offset:8192
    ds_write_b128 v4, v[132:135] offset:9216
    ds_write_b128 v4, v[144:147] offset:10240
    ds_write_b128 v4, v[148:151] offset:11264
    ds_write_b128 v4, v[160:163] offset:12288
    ds_write_b128 v4, v[164:167] offset:13312
    s_xor_b32 s74, s3, 1
    s_mul_i32 s74, s74, 18432
    v_add_u32 v17, s74, v2
    s_xor_b32 s74, s3, 2
    s_mul_i32 s74, s74, 18432
    v_add_u32 v18, s74, v2
    s_xor_b32 s74, s3, 3
    s_mul_i32 s74, s74, 18432
    v_add_u32 v19, s74, v2
    s_xor_b32 s74, s3, 4
    s_mul_i32 s74, s74, 18432
    v_add_u32 v20, s74, v2
    s_xor_b32 s74, s3, 5
    s_mul_i32 s74, s74, 18432
    v_add_u32 v21, s74, v2
    s_xor_b32 s74, s3, 6
    s_mul_i32 s74, s74, 18432
    v_add_u32 v22, s74, v2
    s_xor_b32 s74, s3, 7
    s_mul_i32 s74, s74, 18432
    v_add_u32 v23, s74, v2
    s_waitcnt vmcnt(0)
    v_lshlrev_b32 v24, 16, v96
    v_and_b32 v25, 0xffff0000, v96
    v_lshlrev_b32 v26, 16, v97
    v_and_b32 v27, 0xffff0000, v97
    v_lshlrev_b32 v28, 16, v98
    v_and_b32 v29, 0xffff0000, v98
    v_lshlrev_b32 v30, 16, v99
    v_and_b32 v31, 0xffff0000, v99
    v_add_f32 v104, v104, v24
    v_add_f32 v105, v105, v25
    v_add_f32 v106, v106, v26
    v_add_f32 v107, v107, v27
    v_add_f32 v108, v108, v28
    v_add_f32 v109, v109, v29
    v_add_f32 v110, v110, v30
    v_add_f32 v111, v111, v31
    s_waitcnt lgkmcnt(0)
    s_barrier
    ds_read_b128 v[32:35], v17 offset:0
    ds_read_b128 v[36:39], v17 offset:1024
    ds_read_b128 v[40:43], v18 offset:2048
    ds_read_b128 v[44:47], v18 offset:3072
    ds_read_b128 v[48:51], v19 offset:4096
    ds_read_b128 v[52:55], v19 offset:5120
    ds_read_b128 v[56:59], v20 offset:6144
    ds_read_b128 v[60:63], v20 offset:7168
    ds_read_b128 v[64:67], v21 offset:8192
    ds_read_b128 v[68:71], v21 offset:9216
    ds_read_b128 v[72:75], v22 offset:10240
    ds_read_b128 v[76:79], v22 offset:11264
    ds_read_b128 v[80:83], v23 offset:12288
    ds_read_b128 v[84:87], v23 offset:13312
    s_waitcnt lgkmcnt(13)
    v_pk_add_f32 v[104:105], v[104:105], v[32:33]
    v_pk_add_f32 v[106:107], v[106:107], v[34:35]
    s_waitcnt lgkmcnt(12)
    v_pk_add_f32 v[108:109], v[108:109], v[36:37]
    v_pk_add_f32 v[110:111], v[110:111], v[38:39]
    s_waitcnt lgkmcnt(9)
    v_pk_add_f32 v[40:41], v[40:41], v[48:49]
    v_pk_add_f32 v[42:43], v[42:43], v[50:51]
    s_waitcnt lgkmcnt(8)
    v_pk_add_f32 v[44:45], v[44:45], v[52:53]
    v_pk_add_f32 v[46:47], v[46:47], v[54:55]
    s_waitcnt lgkmcnt(5)
    v_pk_add_f32 v[56:57], v[56:57], v[64:65]
    v_pk_add_f32 v[58:59], v[58:59], v[66:67]
    s_waitcnt lgkmcnt(4)
    v_pk_add_f32 v[60:61], v[60:61], v[68:69]
    v_pk_add_f32 v[62:63], v[62:63], v[70:71]
    s_waitcnt lgkmcnt(1)
    v_pk_add_f32 v[72:73], v[72:73], v[80:81]
    v_pk_add_f32 v[74:75], v[74:75], v[82:83]
    s_waitcnt lgkmcnt(0)
    v_pk_add_f32 v[76:77], v[76:77], v[84:85]
    v_pk_add_f32 v[78:79], v[78:79], v[86:87]
    v_pk_add_f32 v[104:105], v[104:105], v[40:41]
    v_pk_add_f32 v[106:107], v[106:107], v[42:43]
    v_pk_add_f32 v[108:109], v[108:109], v[44:45]
    v_pk_add_f32 v[110:111], v[110:111], v[46:47]
    v_pk_add_f32 v[56:57], v[56:57], v[72:73]
    v_pk_add_f32 v[58:59], v[58:59], v[74:75]
    v_pk_add_f32 v[60:61], v[60:61], v[76:77]
    v_pk_add_f32 v[62:63], v[62:63], v[78:79]
    v_pk_add_f32 v[104:105], v[104:105], v[56:57]
    v_pk_add_f32 v[106:107], v[106:107], v[58:59]
    v_pk_add_f32 v[108:109], v[108:109], v[60:61]
    v_pk_add_f32 v[110:111], v[110:111], v[62:63]
    v_cvt_pk_bf16_f32 v24, v104, v105
    v_cvt_pk_bf16_f32 v25, v106, v107
    v_cvt_pk_bf16_f32 v26, v108, v109
    v_cvt_pk_bf16_f32 v27, v110, v111
    buffer_store_dwordx4 v[24:27], v8, s[28:31], 0 offen
K_kv_fin:
    s_endpgm
K_END:
    s_endpgm
.section .rodata,"a"
.p2align 6
.amdhsa_kernel parallel_sum__linear_kernel_hedgehog__geglu_ffn__prompt_kernel
  .amdhsa_next_free_vgpr 168
  .amdhsa_next_free_sgpr 102
  .amdhsa_accum_offset 168
  .amdhsa_group_segment_fixed_size 0
  .amdhsa_kernarg_size 88
  .amdhsa_user_sgpr_count 2
  .amdhsa_user_sgpr_kernarg_segment_ptr 1
  .amdhsa_system_sgpr_workgroup_id_x 1
.end_amdhsa_kernel
```
